```python
import torch

def _softmax(x, axis=-1):
    return torch.softmax(x, dim=axis)
def _gelu(x):
    return torch.nn.functional.gelu(x, approximate="tanh")
def _silu(x):
    return torch.nn.functional.silu(x)
def _sigmoid(x):
    return torch.sigmoid(x)
def _layernorm(x, axis=-1, eps=1e-5):
    m = x.mean(dim=axis, keepdim=True)
    v = x.var(dim=axis, keepdim=True, unbiased=False)
    return (x - m) / torch.sqrt(v + eps)
def _scatter_add(tgt, idx, src, axis=0):
    return tgt.clone().index_add_(axis, idx, src)
def _segment_sum(src, seg, n):
    out = torch.zeros((n,) + src.shape[1:], dtype=src.dtype)
    return out.index_add_(0, seg, src)
def _pad(x, pw):
    flat = tuple(v for pair in reversed(pw) for v in pair)
    return torch.nn.functional.pad(x, flat)

kernel_name = 'gather_scatter__cheap_equivariant_egnn__graph'

def setup_inputs():

    _w = (lambda a: (lambda t: t.to(torch.bfloat16) if t.is_floating_point() else t)(torch.as_tensor(a)))
    N, deg, D, De = 25000, 16, 128, max(0, 1)
    E = N * deg
    return {
        "h": _w((lambda *s: torch.randn(*s, dtype=torch.bfloat16) * 0.2)(N, D)),
        "pos": _w((lambda *s: torch.randn(*s, dtype=torch.bfloat16) * 0.8)(N, 3)),
        "e_attr": _w((lambda *s: torch.randn(*s, dtype=torch.bfloat16) * 0.8)(E, De)),
        "src": _w((lambda lo, hi, *s: torch.randint(lo, hi, s))(0, N, E).to(torch.int64)),
        "dst": _w((lambda lo, hi, *s: torch.randint(lo, hi, s))(0, N, E).to(torch.int64)),
        "w_e": _w(0.1 * (lambda *s: torch.randn(*s, dtype=torch.bfloat16) * 0.8)(2 * D + 1 + De, D)),
        "w_x": _w(0.1 * (lambda *s: torch.randn(*s, dtype=torch.bfloat16) * 0.2)(D, 1)),
        "w_h": _w(0.1 * (lambda *s: torch.randn(*s, dtype=torch.bfloat16) * 0.2)(2 * D, D)),
    }

def reference(h, pos, e_attr, src, dst, w_e, w_x, w_h):
    N, D = h.shape[0], h.shape[1]
    diff = pos[dst] - pos[src]
    dist2 = torch.sum(diff * diff, axis=-1, keepdims=True)
    e_in = torch.concatenate([h[dst], h[src], dist2, e_attr], axis=-1)
    m_ij = _silu(e_in @ w_e)
    coord_scale = m_ij @ w_x
    pos_new = pos + _segment_sum(diff * coord_scale, dst, N)
    m_i = _segment_sum(m_ij, dst, N)
    h_new = h + _silu(torch.concatenate([h, m_i], axis=-1) @ w_h)
    return h_new, pos_new
```

```asm
; @launch grid=(256,1,1) block=(512,1,1) lds=163840
.amdgcn_target "amdgcn-amd-amdhsa--gfx950"
.text
.globl gather_scatter__cheap_equivariant_egnn__graph_kernel
.p2align 8
.type gather_scatter__cheap_equivariant_egnn__graph_kernel,@function
gather_scatter__cheap_equivariant_egnn__graph_kernel:
    s_cmp_ge_u32 s2, 256
    s_cbranch_scc1 K2_END
    s_load_dwordx16 s[4:19], s[0:1], 0
    s_load_dwordx4 s[20:23], s[0:1], 64
    s_load_dwordx2 s[24:25], s[0:1], 80
    v_lshrrev_b32 v236, 6, v0
    v_and_b32 v1, 63, v0
    v_readfirstlane_b32 s3, v236
    s_nop 0
    s_cmp_lg_u32 s3, 7
    s_cbranch_scc1 NOCPF
    s_cmp_eq_u32 s2, 0
    s_cbranch_scc1 NOCPF
    s_getpc_b64 s[72:73]
CPFB:
    s_bfe_u32 s82, s2, 0x20003
    s_lshl_b32 s82, s82, 13
    v_lshl_add_u32 v94, v1, 7, s82
    s_mov_b32 s82, CODE_END-CPFB
    v_mov_b32 v97, s73
    v_add_co_u32 v96, vcc, s72, v94
    s_nop 1
    v_addc_co_u32 v97, vcc, 0, v97, vcc
    v_cmpx_gt_u32 vcc, s82, v94
    s_cbranch_execz CPFD
    global_load_dword v95, v[96:97], off
CPFD:
    s_mov_b64 exec, -1
NOCPF:
    v_lshlrev_b32 v24, 2, v0
    v_add_u32 v24, 147696, v24
    v_mov_b32 v28, 0
    ds_write_b32 v24, v28
    s_and_b32 s26, s2, 7
    s_lshl_b32 s26, s26, 5
    s_lshr_b32 s82, s2, 3
    s_add_u32 s26, s26, s82
    s_mul_i32 s27, s26, 98
    s_sub_u32 s84, 25000, s27
    s_min_u32 s84, s84, 98
    s_mul_i32 s86, s2, 1568
    s_sub_u32 s82, 400000, s86
    s_lshr_b32 s82, s82, 2
    s_min_u32 s82, s82, 392
    v_cmp_gt_u32 s[80:81], s82, v0
    v_lshlrev_b32 v235, 4, v1
    v_lshlrev_b32 v24, 4, v0
    v_lshlrev_b32 v25, 3, v0
    s_lshl_b32 s82, s86, 2
    s_lshl_b32 s83, s86, 1
    v_lshrrev_b32 v29, 4, v1
    s_and_b32 s85, s3, 3
    s_lshl_b32 s85, s85, 2
    v_add_u32 v31, s85, v29
    v_and_b32 v30, 15, v1
    v_xor_b32 v31, v31, v30
    v_lshlrev_b32 v31, 4, v31
    v_lshl_or_b32 v239, v29, 8, v31
    s_mov_b32 s62, 1600000
    s_mov_b32 s63, 0x20000
    s_mov_b32 s66, 1600000
    s_mov_b32 s67, 0x20000
    s_mov_b32 s70, 800000
    s_mov_b32 s71, 0x20000
    s_waitcnt lgkmcnt(0)
    s_mov_b64 s[60:61], s[12:13]
    s_mov_b64 s[64:65], s[10:11]
    s_mov_b64 s[68:69], s[8:9]
    s_mov_b64 exec, s[80:81]
    s_cbranch_execz NOEDGE
    buffer_load_dwordx4 v[32:35], v24, s[60:63], s82 offen nt
    buffer_load_dwordx4 v[36:39], v24, s[64:67], s82 offen nt
    buffer_load_dwordx2 v[40:41], v25, s[68:71], s83 offen nt
NOEDGE:
    s_mov_b64 exec, -1
    s_cmp_lg_u32 s3, 7
    s_cbranch_scc1 NOZA
    s_cmp_lg_u32 s2, 0
    s_cbranch_scc1 NOZA
    s_add_u32 s52, s24, 11010048
    s_addc_u32 s53, s25, 0
    s_mov_b32 s54, 8192
    s_mov_b32 s55, 0x20000
    v_lshlrev_b32 v31, 4, v235
    buffer_store_dword v28, v31, s[52:55], 0 offen sc1
NOZA:
    s_barrier
    s_lshl_b32 s82, s27, 8
    s_lshl_b32 s83, s84, 8
    s_add_u32 s40, s4, s82
    s_addc_u32 s41, s5, 0
    s_mov_b32 s42, s83
    s_mov_b32 s43, 0x20000
    s_add_u32 s28, s24, s82
    s_addc_u32 s29, s25, 0
    s_mov_b32 s30, s83
    s_mov_b32 s31, 0x20000
    s_mov_b32 s48, s22
    s_mov_b32 s49, s23
    s_mov_b32 s50, 256
    s_mov_b32 s51, 0x20000
    s_add_u32 s52, s24, 11010048
    s_addc_u32 s53, s25, 0
    s_mov_b32 s54, 8192
    s_mov_b32 s55, 0x20000
    s_add_u32 s36, s24, 10223616
    s_addc_u32 s37, s25, 0
    s_mov_b32 s38, 99584
    s_mov_b32 s39, 0x20000
    v_and_b32 v26, 31, v1
    v_lshrrev_b32 v27, 5, v1
    s_cmp_lg_u32 s3, 7
    s_cbranch_scc1 NOW7A
    s_cmp_lg_u32 s2, 0
    s_cbranch_scc1 NOZC
    v_mov_b32 v30, 1
    s_waitcnt vmcnt(0)
    s_mov_b64 exec, 1
    buffer_store_dword v30, v28, s[48:51], 0 offen sc1
    s_mov_b64 exec, -1
NOZC:
    s_cmp_gt_u32 s2, 65
    s_cbranch_scc1 NOW7A
    s_cmp_eq_u32 s2, 64
    s_cbranch_scc1 PI_CST
    s_cmp_eq_u32 s2, 65
    s_cbranch_scc1 PI_WX
    s_mov_b32 s60, s18
    s_mov_b32 s61, s19
    s_mov_b32 s62, 65536
    s_mov_b32 s63, 0x20000
    s_bfe_u32 s64, s2, 0x10004
    s_bfe_u32 s65, s2, 0x10003
    s_and_b32 s66, s2, 7
    s_lshl_b32 s64, s64, 6
    s_add_u32 s64, s64, s65
    v_lshl_add_u32 v62, v26, 1, s64
    v_lshlrev_b32 v62, 1, v62
    s_lshl_b32 s67, s66, 4
    s_lshr_b32 s68, s66, 2
    s_lshl_b32 s68, s68, 6
    s_and_b32 s69, s66, 3
    s_lshl_b32 s69, s69, 3
    s_add_u32 s68, s68, s69
    s_add_u32 s68, s68, 128
    s_cmp_ge_u32 s2, 32
    s_cselect_b32 s67, s68, s67
    s_cselect_b32 s68, 9, 11
    v_lshlrev_b32 v63, s68, v27
    s_lshl_b32 s67, s67, 8
    v_add3_u32 v62, v62, v63, s67
    s_cmp_ge_u32 s2, 32
    s_mov_b32 s69, 0
    s_cselect_b32 s69, 0, s69
    buffer_load_ushort v64, v62, s[60:63], s69 offen
    s_mov_b32 s69, 256
    s_cselect_b32 s69, 8192, s69
    buffer_load_ushort v65, v62, s[60:63], s69 offen
    s_mov_b32 s69, 512
    s_cselect_b32 s69, 256, s69
    buffer_load_ushort v66, v62, s[60:63], s69 offen
    s_mov_b32 s69, 768
    s_cselect_b32 s69, 8448, s69
    buffer_load_ushort v67, v62, s[60:63], s69 offen
    s_mov_b32 s69, 1024
    s_cselect_b32 s69, 1024, s69
    buffer_load_ushort v68, v62, s[60:63], s69 offen
    s_mov_b32 s69, 1280
    s_cselect_b32 s69, 9216, s69
    buffer_load_ushort v69, v62, s[60:63], s69 offen
    s_mov_b32 s69, 1536
    s_cselect_b32 s69, 1280, s69
    buffer_load_ushort v70, v62, s[60:63], s69 offen
    s_mov_b32 s69, 1792
    s_cselect_b32 s69, 9472, s69
    buffer_load_ushort v71, v62, s[60:63], s69 offen
    s_branch PI_DONE
PI_CST:
    s_add_u32 s60, s14, 65536
    s_addc_u32 s61, s15, 0
    s_mov_b32 s62, 512
    s_mov_b32 s63, 0x20000
    v_and_b32 v62, 1, v26
    v_lshlrev_b32 v62, 5, v62
    v_lshrrev_b32 v63, 1, v26
    v_add_lshl_u32 v62, v62, v63, 1
    buffer_load_ushort v64, v62, s[60:63], 0 offen offset:0
    buffer_load_ushort v65, v62, s[60:63], 0 offen offset:256
    buffer_load_ushort v66, v62, s[60:63], 0 offen offset:32
    buffer_load_ushort v67, v62, s[60:63], 0 offen offset:288
    buffer_load_ushort v68, v62, s[60:63], 0 offen offset:128
    buffer_load_ushort v69, v62, s[60:63], 0 offen offset:384
    buffer_load_ushort v70, v62, s[60:63], 0 offen offset:160
    buffer_load_ushort v71, v62, s[60:63], 0 offen offset:416
    s_branch PI_DONE
PI_WX:
    s_mov_b32 s60, s16
    s_mov_b32 s61, s17
    s_mov_b32 s62, 256
    s_mov_b32 s63, 0x20000
    v_bfe_u32 v62, v1, 3, 1
    v_lshlrev_b32 v62, 6, v62
    v_bfe_u32 v63, v1, 1, 2
    v_lshl_or_b32 v62, v63, 3, v62
    v_and_b32 v63, 1, v1
    v_or_b32 v62, v63, v62
    v_lshlrev_b32 v62, 1, v62
    buffer_load_ushort v64, v62, s[60:63], 0 offen offset:0
    buffer_load_ushort v65, v62, s[60:63], 0 offen offset:64
    buffer_load_ushort v66, v62, s[60:63], 0 offen offset:8
    buffer_load_ushort v67, v62, s[60:63], 0 offen offset:72
    buffer_load_ushort v68, v62, s[60:63], 0 offen offset:4
    buffer_load_ushort v69, v62, s[60:63], 0 offen offset:68
    buffer_load_ushort v70, v62, s[60:63], 0 offen offset:12
    buffer_load_ushort v71, v62, s[60:63], 0 offen offset:76
PI_DONE:
NOW7A:
    v_lshrrev_b32 v96, 4, v1
    v_bfe_u32 v97, v1, 2, 2
    v_xor_b32 v97, v97, v96
    v_lshlrev_b32 v97, 6, v97
    v_and_b32 v98, 3, v1
    v_lshl_or_b32 v97, v98, 4, v97
    v_lshl_or_b32 v238, v96, 8, v97
    s_mov_b32 s72, s14
    s_mov_b32 s73, s15
    s_mov_b32 s74, 65536
    s_mov_b32 s75, 0x20000
    s_lshl_b32 s82, s3, 10
    s_add_u32 m0, s82, 3072
    s_add_u32 s83, s82, 0
    buffer_load_dwordx4 v239, s[40:43], s83 offen lds
    s_add_u32 m0, s82, 11264
    s_add_u32 s83, s82, 8192
    buffer_load_dwordx4 v239, s[40:43], s83 offen lds
    s_add_u32 m0, s82, 19456
    s_add_u32 s83, s82, 16384
    buffer_load_dwordx4 v239, s[40:43], s83 offen lds
    v_mov_b32 v29, 0
    v_mov_b32 v30, 0
    v_mov_b32 v31, 0
    v_add_u32 v25, 121040, v24
    ds_write_b128 v25, v[28:31] offset:0
    ds_write_b128 v25, v[28:31] offset:8192
    ds_write_b128 v25, v[28:31] offset:16384
    v_cmpx_gt_u32 vcc, 130, v0
    ds_write_b128 v25, v[28:31] offset:24576
    v_cmpx_gt_u32 vcc, 70, v0
    ds_write_b128 v24, v[28:31] offset:1568
    s_mov_b64 exec, -1
    s_add_u32 s32, s24, 6553600
    s_addc_u32 s33, s25, 0
    s_mov_b32 s34, 3211264
    s_mov_b32 s35, 0x20000
    s_add_u32 s56, s24, 9961472
    s_addc_u32 s57, s25, 0
    s_mov_b32 s58, 262144
    s_mov_b32 s59, 0x20000
    s_lshl_b32 s82, s27, 4
    s_add_u32 s82, s82, 10485760
    s_lshl_b32 s83, s84, 4
    s_add_u32 s44, s24, s82
    s_addc_u32 s45, s25, 0
    s_mov_b32 s46, s83
    s_mov_b32 s47, 0x20000
    s_mov_b32 s78, 0x88888888
    s_mov_b32 s79, 0x88888888
    s_lshl_b32 s87, s3, 13
    s_add_u32 s87, s87, 28672
    s_mov_b32 s76, 0xbfb8aa3b
    v_mov_b32 v92, 0
    s_mov_b64 exec, s[80:81]
    s_cbranch_execz NOCH
    s_movk_i32 s82, 10700
    s_mov_b32 s83, 147696
    v_mov_b32 v23, 1
    s_waitcnt vmcnt(5)
    v_mul_u32_u24 v42, s82, v32
    v_lshrrev_b32 v42, 20, v42
    v_lshl_add_u32 v46, v42, 2, s83
    ds_add_rtn_u32 v50, v46, v23
    v_mul_u32_u24 v43, s82, v33
    v_lshrrev_b32 v43, 20, v43
    v_lshl_add_u32 v47, v43, 2, s83
    ds_add_rtn_u32 v51, v47, v23
    v_mul_u32_u24 v44, s82, v34
    v_lshrrev_b32 v44, 20, v44
    v_lshl_add_u32 v48, v44, 2, s83
    ds_add_rtn_u32 v52, v48, v23
    v_mul_u32_u24 v45, s82, v35
    v_lshrrev_b32 v45, 20, v45
    v_lshl_add_u32 v49, v45, 2, s83
    ds_add_rtn_u32 v53, v49, v23
NOCH:
    s_mov_b64 exec, -1
    v_add_u32 v24, 147696, v235
    s_waitcnt lgkmcnt(0)
    s_barrier
    ds_read_b128 v[80:83], v24
    s_movk_i32 s82, -98
    v_mad_i32_i24 v32, v42, s82, v32
    v_lshlrev_b32 v32, 2, v32
    v_mad_i32_i24 v33, v43, s82, v33
    v_lshlrev_b32 v33, 2, v33
    v_mad_i32_i24 v34, v44, s82, v34
    v_lshlrev_b32 v34, 2, v34
    v_mad_i32_i24 v35, v45, s82, v35
    v_lshlrev_b32 v35, 2, v35
    s_waitcnt lgkmcnt(0)
    v_add_u32 v84, v80, v81
    v_add_u32 v86, v84, v82
    v_add_u32 v85, v86, v83
    v_mov_b32 v87, v85
    s_nop 1
    v_add_u32_dpp v87, v87, v87 row_shr:1 row_mask:0xf bank_mask:0xf bound_ctrl:1
    s_nop 1
    v_add_u32_dpp v87, v87, v87 row_shr:2 row_mask:0xf bank_mask:0xf bound_ctrl:1
    s_nop 1
    v_add_u32_dpp v87, v87, v87 row_shr:4 row_mask:0xf bank_mask:0xf bound_ctrl:1
    s_nop 1
    v_add_u32_dpp v87, v87, v87 row_shr:8 row_mask:0xf bank_mask:0xf bound_ctrl:1
    s_nop 1
    v_add_u32_dpp v87, v87, v87 row_bcast:15 row_mask:0xa bank_mask:0xf
    s_nop 1
    v_add_u32_dpp v87, v87, v87 row_bcast:31 row_mask:0xc bank_mask:0xf
    v_subrev_u32 v85, 18718, v85
    v_sub_u32 v88, v87, v85
    v_add_u32 v89, v88, v80
    v_add_u32 v90, v88, v84
    v_add_u32 v91, v88, v86
    ds_write_b128 v24, v[88:91] offset:1024
    s_lshl_b32 s82, s3, 12
    s_add_u32 m0, s82, 28672
    s_add_u32 s83, s82, 32768
    buffer_load_dwordx4 v238, s[72:75], s83 offen lds
    s_add_u32 m0, s82, 29696
    s_add_u32 s83, s82, 33792
    buffer_load_dwordx4 v238, s[72:75], s83 offen lds
    s_add_u32 m0, s82, 30720
    s_add_u32 s83, s82, 34816
    buffer_load_dwordx4 v238, s[72:75], s83 offen lds
    s_add_u32 m0, s82, 31744
    s_add_u32 s83, s82, 35840
    buffer_load_dwordx4 v238, s[72:75], s83 offen lds
    s_cmp_eq_u32 s3, 7
    s_cbranch_scc1 W7B
    s_mov_b64 exec, s[80:81]
    s_cbranch_execz NOSCAT
    ds_read_b32 v42, v46 offset:1024
    ds_read_b32 v43, v47 offset:1024
    ds_read_b32 v44, v48 offset:1024
    ds_read_b32 v45, v49 offset:1024
    s_mov_b32 s82, 0xffff0000
    s_waitcnt vmcnt(7)
    v_lshl_or_b32 v55, v36, 15, v32
    v_lshlrev_b32 v55, 1, v55
    v_lshl_or_b32 v54, v40, 16, v32
    v_lshl_or_b32 v57, v37, 15, v33
    v_lshlrev_b32 v57, 1, v57
    v_and_or_b32 v56, v40, s82, v33
    v_lshl_or_b32 v59, v38, 15, v34
    v_lshlrev_b32 v59, 1, v59
    v_lshl_or_b32 v58, v41, 16, v34
    v_lshl_or_b32 v61, v39, 15, v35
    v_lshlrev_b32 v61, 1, v61
    v_and_or_b32 v60, v41, s82, v35
    s_waitcnt lgkmcnt(3)
    v_add_lshl_u32 v42, v42, v50, 3
    ds_write_b64 v42, v[54:55]
    s_waitcnt lgkmcnt(3)
    v_add_lshl_u32 v43, v43, v51, 3
    ds_write_b64 v43, v[56:57]
    s_waitcnt lgkmcnt(3)
    v_add_lshl_u32 v44, v44, v52, 3
    ds_write_b64 v44, v[58:59]
    s_waitcnt lgkmcnt(3)
    v_add_lshl_u32 v45, v45, v53, 3
    ds_write_b64 v45, v[60:61]
    s_branch NOSCAT
W7B:
    v_subrev_u32 v88, 18718, v88
    v_lshl_or_b32 v88, v80, 16, v88
    v_subrev_u32 v89, 18718, v89
    v_lshl_or_b32 v89, v81, 16, v89
    v_subrev_u32 v90, 18718, v90
    v_lshl_or_b32 v90, v82, 16, v90
    v_subrev_u32 v91, 18718, v91
    v_lshl_or_b32 v91, v83, 16, v91
    s_lshl_b32 s82, s2, 4
    v_lshlrev_b32 v94, 12, v1
    buffer_store_dwordx4 v[88:91], v94, s[56:59], s82 offen sc1
NOSCAT:
    s_mov_b64 exec, -1
    v_lshlrev_b32 v24, 4, v0
    v_add_u32 v25, 149744, v24
    v_cmp_gt_u32 vcc, 272, v0
    s_mul_i32 s82, s2, 12544
    s_add_u32 s83, s82, 8192
    s_waitcnt lgkmcnt(0)
    s_barrier
    ds_read_b128 v[32:35], v25
    s_mov_b64 exec, vcc
    ds_read_b128 v[36:39], v25 offset:8192
    s_mov_b64 exec, -1
    s_waitcnt lgkmcnt(0)
    buffer_store_dwordx4 v[32:35], v24, s[32:35], s82 offen sc0 sc1
    s_mov_b64 exec, vcc
    buffer_store_dwordx4 v[36:39], v24, s[32:35], s83 offen sc0 sc1
    s_mov_b64 exec, -1
    s_cmp_lg_u32 s3, 7
    s_cbranch_scc1 X0
    s_cmp_gt_u32 s2, 65
    s_cbranch_scc1 X0
    s_waitcnt vmcnt(9)
    s_lshl_b32 s64, s2, 10
    s_add_u32 s64, s64, 32768
    s_cmp_eq_u32 s2, 64
    s_cbranch_scc1 PF_CST
    v_lshl_or_b32 v72, v65, 16, v64
    v_lshl_or_b32 v73, v67, 16, v66
    v_lshl_or_b32 v74, v69, 16, v68
    v_lshl_or_b32 v75, v71, 16, v70
    s_branch PF_ST
PF_CST:
    v_cmp_gt_u32 vcc, 32, v1
    v_lshlrev_b32 v64, 16, v64
    v_lshlrev_b32 v65, 16, v65
    v_mul_f32 v76, s76, v64
    v_mul_f32 v77, s76, v65
    v_cvt_pk_bf16_f32 v78, v76, v77
    v_lshlrev_b32 v79, 16, v78
    v_and_b32 v80, 0xffff0000, v78
    v_fma_f32 v76, s76, v64, -v79
    v_fma_f32 v77, s76, v65, -v80
    v_cvt_pk_bf16_f32 v79, v76, v77
    v_cndmask_b32 v72, v79, v78, vcc
    v_lshlrev_b32 v66, 16, v66
    v_lshlrev_b32 v67, 16, v67
    v_mul_f32 v76, s76, v66
    v_mul_f32 v77, s76, v67
    v_cvt_pk_bf16_f32 v78, v76, v77
    v_lshlrev_b32 v79, 16, v78
    v_and_b32 v80, 0xffff0000, v78
    v_fma_f32 v76, s76, v66, -v79
    v_fma_f32 v77, s76, v67, -v80
    v_cvt_pk_bf16_f32 v79, v76, v77
    v_cndmask_b32 v73, v79, v78, vcc
    v_lshlrev_b32 v68, 16, v68
    v_lshlrev_b32 v69, 16, v69
    v_mul_f32 v76, s76, v68
    v_mul_f32 v77, s76, v69
    v_cvt_pk_bf16_f32 v78, v76, v77
    v_lshlrev_b32 v79, 16, v78
    v_and_b32 v80, 0xffff0000, v78
    v_fma_f32 v76, s76, v68, -v79
    v_fma_f32 v77, s76, v69, -v80
    v_cvt_pk_bf16_f32 v79, v76, v77
    v_cndmask_b32 v74, v79, v78, vcc
    v_lshlrev_b32 v70, 16, v70
    v_lshlrev_b32 v71, 16, v71
    v_mul_f32 v76, s76, v70
    v_mul_f32 v77, s76, v71
    v_cvt_pk_bf16_f32 v78, v76, v77
    v_lshlrev_b32 v79, 16, v78
    v_and_b32 v80, 0xffff0000, v78
    v_fma_f32 v76, s76, v70, -v79
    v_fma_f32 v77, s76, v71, -v80
    v_cvt_pk_bf16_f32 v79, v76, v77
    v_cndmask_b32 v75, v79, v78, vcc
PF_ST:
    buffer_store_dwordx4 v[72:75], v235, s[36:39], s64 offen sc1
X0:
    s_mov_b32 s60, s6
    s_mov_b32 s61, s7
    s_mov_b32 s62, 150000
    s_mov_b32 s63, 0x20000
    v_add_u32 v62, s27, v0
    v_mul_u32_u24 v62, 6, v62
    v_and_b32 v63, -4, v62
    s_cmp_gt_u32 s3, 1
    s_cselect_b32 s62, 0, s62
    buffer_load_dwordx2 v[236:237], v63, s[60:63], 0 offen
    v_lshlrev_b32 v62, 3, v62
    s_mov_b32 m0, 27648
    s_movk_i32 s83, 24576
    s_cmp_eq_u32 s3, 0
    s_cbranch_scc0 X1
    buffer_load_dwordx4 v239, s[40:43], s83 offen lds
X1:
    s_cmp_lg_u32 s3, 7
    s_cbranch_scc1 X1D
    buffer_load_dword v93, v92, s[48:51], 0 offen sc1
X1D:
    v_mov_b32 v28, 0x3f80
    v_mov_b32 v29, 0
    v_bfe_u32 v24, v26, 3, 1
    v_xor_b32 v24, v24, v27
    v_lshlrev_b32 v24, 2, v24
    v_lshrrev_b32 v25, 4, v26
    v_lshl_or_b32 v24, v25, 1, v24
    v_bfe_u32 v25, v26, 2, 1
    v_or_b32 v24, v24, v25
    v_cmp_eq_u32 vcc, 0, v24
    v_mov_b32 v195, 0
    s_nop 0
    v_cndmask_b32 v208, 0, v28, vcc
    v_cmp_eq_u32 vcc, 1, v24
    v_mov_b32 v199, 0
    s_nop 0
    v_cndmask_b32 v209, 0, v28, vcc
    v_cmp_eq_u32 vcc, 2, v24
    v_mov_b32 v203, 0
    s_nop 0
    v_cndmask_b32 v210, 0, v28, vcc
    v_cmp_eq_u32 vcc, 3, v24
    v_mov_b32 v207, 0
    s_nop 0
    v_cndmask_b32 v211, 0, v28, vcc
    v_and_b32 v24, 3, v26
    v_mul_u32_u24 v212, 0x1111, v24
    v_lshrrev_b32 v18, 2, v26
    v_lshlrev_b32 v24, 2, v27
    v_sub_u32 v24, v18, v24
    v_lshlrev_b32 v25, 4, v24
    v_lshlrev_b64 v[28:29], v25, v[28:29]
    v_cmp_gt_u32 vcc, 4, v24
    v_mov_b32 v232, 0
    v_mov_b32 v233, 0
    v_mov_b32 v219, 0
    v_cndmask_b32 v28, 0, v28, vcc
    v_cndmask_b32 v29, 0, v29, vcc
    v_cndmask_b32 v230, 0, v28, s[78:79]
    v_cndmask_b32 v231, 0, v29, s[78:79]
    v_lshlrev_b32 v10, 6, v27
    v_lshl_add_u32 v24, v18, 3, v10
    s_mov_b64 exec, s[78:79]
    ds_write_b64 v24, v[28:29] offset:2688
    s_mov_b64 exec, -1
    s_mov_b32 s76, 0xbfb8aa3b
    s_mov_b32 s77, 0xbfb8aa3b
    s_lshr_b32 s82, s3, 1
    s_mul_i32 s85, s82, 24
    s_cmp_eq_u32 s82, 0
    s_cselect_b32 s82, 0, 8
    s_add_u32 s85, s85, s82
    s_lshl_b32 s82, s85, 8
    s_and_b32 s83, s3, 1
    s_lshl_b32 s83, s83, 7
    s_add_u32 s86, s83, s82
    s_add_u32 s82, s86, 94208
    v_lshlrev_b32 v25, 10, v27
    v_lshl_or_b32 v25, v26, 2, v25
    v_add_u32 v234, s82, v25
    v_add_u32 v24, s85, v26
    v_and_b32 v25, 15, v24
    v_xor_b32 v25, v25, v27
    v_lshlrev_b32 v25, 4, v25
    v_lshl_or_b32 v25, v24, 8, v25
    v_add_u32 v222, 3072, v25
    v_xor_b32 v223, 32, v222
    v_xor_b32 v224, 64, v222
    v_xor_b32 v225, 96, v222
    v_xor_b32 v226, 128, v222
    v_xor_b32 v227, 160, v222
    v_xor_b32 v228, 192, v222
    v_xor_b32 v229, 224, v222
    v_bfe_u32 v24, v1, 2, 2
    v_lshl_add_u32 v25, v27, 4, v24
    v_lshlrev_b32 v25, 7, v25
    v_lshrrev_b32 v24, 1, v24
    v_lshl_or_b32 v25, v24, 6, v25
    v_bfe_u32 v24, v1, 4, 1
    v_lshl_or_b32 v25, v24, 5, v25
    v_and_b32 v30, 3, v1
    v_lshl_or_b32 v25, v30, 3, v25
    v_add_u32 v3, s87, v25
    v_xor_b32 v4, 64, v3
    v_and_b32 v25, 7, v1
    v_lshlrev_b32 v24, 2, v24
    v_xor_b32 v25, v25, v24
    v_lshlrev_b32 v5, 4, v25
    v_and_b32 v24, 3, v1
    s_lshl_b32 s82, s3, 11
    s_add_u32 s82, s82, 3072
    v_bfe_u32 v25, v26, 1, 3
    v_lshlrev_b32 v25, 3, v25
    v_lshl_or_b32 v25, v26, 6, v25
    v_add_u32 v11, s82, v25
    v_bfe_u32 v28, v1, 2, 2
    v_bfe_u32 v29, v1, 4, 1
    v_lshl_add_u32 v15, v27, 2, v28
    v_lshl_or_b32 v25, v29, 2, v24
    v_lshrrev_b32 v30, 1, v15
    v_xor_b32 v25, v25, v30
    v_lshlrev_b32 v25, 3, v25
    v_lshl_or_b32 v25, v15, 6, v25
    v_add_u32 v13, s82, v25
    v_xor_b32 v14, 32, v13
    v_lshlrev_b32 v25, 5, v29
    v_lshl_or_b32 v30, v24, 3, v25
    v_add_u32 v16, 94208, v30
    v_lshl_add_u32 v31, v27, 3, v28
    v_lshl_or_b32 v31, v31, 8, v30
    s_and_b32 s83, s3, 1
    s_lshl_b32 s82, s83, 1
    v_xor_b32 v28, s82, v28
    v_lshl_or_b32 v31, v28, 6, v31
    v_add_u32 v6, 28672, v31
    v_xor_b32 v7, 64, v6
    v_and_b32 v30, 1, v24
    v_lshl_or_b32 v25, v30, 4, v25
    v_lshrrev_b32 v30, 1, v24
    v_lshl_or_b32 v17, v30, 3, v25
    v_lshlrev_b32 v22, 4, v27
    v_and_b32 v214, 1, v1
    v_lshl_or_b32 v213, v27, 1, v214
    v_lshlrev_b32 v213, 4, v213
    v_mul_u32_u24 v214, 0xaaaa, v214
    v_add_u32 v214, 0x4444, v214
    v_lshlrev_b32 v24, 2, v24
    v_add_u32 v19, 0x100, v24
    s_lshl_b32 s83, s83, 14
    s_add_u32 s83, s83, 28672
    v_add_u32 v12, s83, v235
    s_lshl_b32 s82, s3, 12
    s_add_u32 m0, s82, 61440
    s_add_u32 s83, s82, 0
    buffer_load_dwordx4 v238, s[72:75], s83 offen lds
    s_add_u32 m0, s82, 62464
    s_add_u32 s83, s82, 1024
    buffer_load_dwordx4 v238, s[72:75], s83 offen lds
    s_add_u32 m0, s82, 63488
    s_add_u32 s83, s82, 2048
    buffer_load_dwordx4 v238, s[72:75], s83 offen lds
    s_add_u32 m0, s82, 64512
    s_add_u32 s83, s82, 3072
    buffer_load_dwordx4 v238, s[72:75], s83 offen lds
    s_waitcnt vmcnt(4)
    s_cmp_lg_u32 s3, 7
    s_cbranch_scc1 X3
    s_mov_b32 s83, 2097152
FLAGW:
    v_readfirstlane_b32 s82, v93
    s_nop 0
    s_cmp_lg_u32 s82, 0
    s_cbranch_scc1 X3
    buffer_load_dword v93, v92, s[48:51], 0 offen sc1
    s_waitcnt vmcnt(0)
    s_sub_u32 s83, s83, 1
    s_cbranch_scc0 FLAGW
X3:
    s_barrier
    s_cmp_lg_u32 s3, 7
    s_cbranch_scc1 X4
    s_and_b32 s82, s2, 15
    s_lshl_b32 s82, s82, 8
    s_add_u32 s82, s82, 0
    s_mov_b64 exec, 1
    v_mov_b32 v30, s82
    v_mov_b32 v31, 1
    buffer_atomic_add v31, v30, s[52:55], 0 offen sc1
    s_mov_b64 exec, -1
X4:
    ds_read_b128 v[160:163], v222
    ds_read_b64_tr_b16 v[64:65], v6 offset:0
    ds_read_b64_tr_b16 v[66:67], v6 offset:1024
    ds_read_b64_tr_b16 v[96:97], v7 offset:0
    ds_read_b64_tr_b16 v[98:99], v7 offset:1024
    ds_read_b128 v[164:167], v223
    ds_read_b64_tr_b16 v[68:69], v6 offset:4096
    ds_read_b64_tr_b16 v[70:71], v6 offset:5120
    ds_read_b64_tr_b16 v[100:101], v7 offset:4096
    ds_read_b64_tr_b16 v[102:103], v7 offset:5120
    ds_read_b128 v[168:171], v224
    ds_read_b64_tr_b16 v[72:73], v6 offset:8192
    ds_read_b64_tr_b16 v[74:75], v6 offset:9216
    ds_read_b64_tr_b16 v[104:105], v7 offset:8192
    ds_read_b64_tr_b16 v[106:107], v7 offset:9216
    s_cmp_gt_u32 s3, 1
    s_cbranch_scc1 X2
    v_alignbit_b32 v41, v237, v236, v62
    v_lshrrev_b32 v42, v62, v237
    v_lshlrev_b32 v40, 16, v41
    v_and_b32 v41, 0xffff0000, v41
    v_lshlrev_b32 v42, 16, v42
    v_mov_b32 v43, 0
    v_lshlrev_b32 v24, 4, v0
    buffer_store_dwordx4 v[40:43], v24, s[44:47], 0 offen sc1
    s_waitcnt lgkmcnt(10)
    v_cmpx_gt_u32 vcc, 98, v0
    v_lshlrev_b32 v25, 3, v0
    ds_write2_b64 v25, v[40:41], v[42:43] offset0:0 offset1:98
    s_mov_b64 exec, -1
    s_waitcnt lgkmcnt(0)
X2:
    s_waitcnt lgkmcnt(10)
    v_mfma_f32_32x32x16_bf16 v[128:143], v[160:163], v[64:67], 0
    v_mfma_f32_32x32x16_bf16 v[144:159], v[160:163], v[96:99], 0
    ds_read_b128 v[172:175], v225
    ds_read_b64_tr_b16 v[76:77], v6 offset:12288
    ds_read_b64_tr_b16 v[78:79], v6 offset:13312
    ds_read_b64_tr_b16 v[108:109], v7 offset:12288
    ds_read_b64_tr_b16 v[110:111], v7 offset:13312
    s_waitcnt lgkmcnt(10)
    v_mfma_f32_32x32x16_bf16 v[128:143], v[164:167], v[68:71], v[128:143]
    v_mfma_f32_32x32x16_bf16 v[144:159], v[164:167], v[100:103], v[144:159]
    ds_read_b128 v[176:179], v226
    ds_read_b64_tr_b16 v[80:81], v6 offset:16384
    ds_read_b64_tr_b16 v[82:83], v6 offset:17408
    ds_read_b64_tr_b16 v[112:113], v7 offset:16384
    ds_read_b64_tr_b16 v[114:115], v7 offset:17408
    s_waitcnt lgkmcnt(10)
    v_mfma_f32_32x32x16_bf16 v[128:143], v[168:171], v[72:75], v[128:143]
    v_mfma_f32_32x32x16_bf16 v[144:159], v[168:171], v[104:107], v[144:159]
    ds_read_b128 v[180:183], v227
    ds_read_b64_tr_b16 v[84:85], v6 offset:20480
    ds_read_b64_tr_b16 v[86:87], v6 offset:21504
    ds_read_b64_tr_b16 v[116:117], v7 offset:20480
    ds_read_b64_tr_b16 v[118:119], v7 offset:21504
    s_waitcnt lgkmcnt(10)
    v_mfma_f32_32x32x16_bf16 v[128:143], v[172:175], v[76:79], v[128:143]
    v_mfma_f32_32x32x16_bf16 v[144:159], v[172:175], v[108:111], v[144:159]
    ds_read_b128 v[184:187], v228
    ds_read_b64_tr_b16 v[88:89], v6 offset:24576
    ds_read_b64_tr_b16 v[90:91], v6 offset:25600
    ds_read_b64_tr_b16 v[120:121], v7 offset:24576
    ds_read_b64_tr_b16 v[122:123], v7 offset:25600
    s_waitcnt lgkmcnt(10)
    v_mfma_f32_32x32x16_bf16 v[128:143], v[176:179], v[80:83], v[128:143]
    v_mfma_f32_32x32x16_bf16 v[144:159], v[176:179], v[112:115], v[144:159]
    ds_read_b128 v[188:191], v229
    ds_read_b64_tr_b16 v[92:93], v6 offset:28672
    ds_read_b64_tr_b16 v[94:95], v6 offset:29696
    ds_read_b64_tr_b16 v[124:125], v7 offset:28672
    ds_read_b64_tr_b16 v[126:127], v7 offset:29696
    s_add_u32 s83, s3, 1
    s_and_b32 s83, s83, 7
    s_cmp_gt_u32 s83, 2
    s_cbranch_scc1 X2B
    s_waitcnt vmcnt(1)
    s_branch X2C
X2B:
    s_waitcnt vmcnt(0)
X2C:
    s_barrier
    s_waitcnt lgkmcnt(10)
    v_mfma_f32_32x32x16_bf16 v[128:143], v[180:183], v[84:87], v[128:143]
    v_mfma_f32_32x32x16_bf16 v[144:159], v[180:183], v[116:119], v[144:159]
    s_movk_i32 s66, 256
    s_movk_i32 s67, 272
    s_mov_b32 s63, 1
    s_mov_b32 s16, 0x7f000000
    s_mov_b32 s8, 0x77777777
    s_mov_b32 s9, 0
    s_mov_b32 s10, -1
    s_mov_b32 s11, 0
    s_cmp_lt_u32 s3, 4
    s_cselect_b32 s68, 2, 0
    s_lshl_b32 s82, s3, 11
    s_add_u32 s22, s82, 3072
    s_add_u32 s23, s82, 11264
    s_add_u32 s82, s87, 2048
    s_cmp_lt_u32 s3, 4
    s_cselect_b32 s22, s87, s22
    s_cselect_b32 s23, s82, s23
    v_lshrrev_b32 v28, 7, v235
    v_and_b32 v29, 0x70, v235
    v_lshl_or_b32 v28, v28, 8, v29
    s_add_u32 s82, s86, 94208
    v_add_u32 v29, s82, v28
    ds_read_b64_tr_b16 v[64:65], v6 offset:32768
    ds_read_b64_tr_b16 v[66:67], v6 offset:33792
    ds_read_b64_tr_b16 v[96:97], v7 offset:32768
    ds_read_b64_tr_b16 v[98:99], v7 offset:33792
    s_waitcnt lgkmcnt(9)
    v_mfma_f32_32x32x16_bf16 v[128:143], v[184:187], v[88:91], v[128:143]
    v_mfma_f32_32x32x16_bf16 v[144:159], v[184:187], v[120:123], v[144:159]
    ds_read_b64_tr_b16 v[68:69], v6 offset:36864
    ds_read_b64_tr_b16 v[70:71], v6 offset:37888
    ds_read_b64_tr_b16 v[100:101], v7 offset:36864
    ds_read_b64_tr_b16 v[102:103], v7 offset:37888
    s_waitcnt lgkmcnt(8)
    v_mfma_f32_32x32x16_bf16 v[128:143], v[188:191], v[92:95], v[128:143]
    v_mfma_f32_32x32x16_bf16 v[144:159], v[188:191], v[124:127], v[144:159]
    ds_read_b64_tr_b16 v[72:73], v6 offset:40960
    ds_read_b64_tr_b16 v[74:75], v6 offset:41984
    ds_read_b64_tr_b16 v[104:105], v7 offset:40960
    ds_read_b64_tr_b16 v[106:107], v7 offset:41984
    s_cmp_lg_u32 s3, 7
    s_cbranch_scc1 X5
    v_lshlrev_b32 v24, 4, v235
    s_movk_i32 s0, 0
    s_mov_b64 exec, 0xffff
    buffer_load_dword v25, v24, s[52:55], s0 offen sc1
    s_mov_b64 exec, -1
X5:
    s_waitcnt lgkmcnt(8)
    v_mfma_f32_32x32x16_bf16 v[32:47], v[160:163], v[64:67], 0
    v_mfma_f32_32x32x16_bf16 v[48:63], v[160:163], v[96:99], 0
    ds_read_b64_tr_b16 v[76:77], v6 offset:45056
    ds_read_b64_tr_b16 v[78:79], v6 offset:46080
    ds_read_b64_tr_b16 v[108:109], v7 offset:45056
    ds_read_b64_tr_b16 v[110:111], v7 offset:46080
    v_mul_f32 v128, s76, v128
    v_mul_f32 v144, s76, v144
    v_mul_f32 v129, s76, v129
    v_mul_f32 v145, s76, v145
    v_cvt_pk_bf16_f32 v128, v128, v144
    v_cvt_pk_bf16_f32 v129, v129, v145
    ds_write2st64_b32 v234, v128, v129 offset0:0 offset1:1
    v_mul_f32 v130, s76, v130
    v_mul_f32 v146, s76, v146
    v_mul_f32 v131, s76, v131
    v_mul_f32 v147, s76, v147
    v_cvt_pk_bf16_f32 v130, v130, v146
    v_cvt_pk_bf16_f32 v131, v131, v147
    ds_write2st64_b32 v234, v130, v131 offset0:2 offset1:3
    ds_read_b128 v[144:147], v29 offset:0
    s_waitcnt lgkmcnt(11)
    v_mfma_f32_32x32x16_bf16 v[32:47], v[164:167], v[68:71], v[32:47]
    v_mfma_f32_32x32x16_bf16 v[48:63], v[164:167], v[100:103], v[48:63]
    ds_read_b64_tr_b16 v[80:81], v6 offset:49152
    ds_read_b64_tr_b16 v[82:83], v6 offset:50176
    ds_read_b64_tr_b16 v[112:113], v7 offset:49152
    ds_read_b64_tr_b16 v[114:115], v7 offset:50176
    v_mul_f32 v132, s76, v132
    v_mul_f32 v148, s76, v148
    v_mul_f32 v133, s76, v133
    v_mul_f32 v149, s76, v149
    v_cvt_pk_bf16_f32 v132, v132, v148
    v_cvt_pk_bf16_f32 v133, v133, v149
    s_waitcnt lgkmcnt(11)
    ds_write2st64_b32 v234, v132, v133 offset0:8 offset1:9
    v_mul_f32 v134, s76, v134
    v_mul_f32 v150, s76, v150
    v_mul_f32 v135, s76, v135
    v_mul_f32 v151, s76, v151
    v_cvt_pk_bf16_f32 v134, v134, v150
    v_cvt_pk_bf16_f32 v135, v135, v151
    ds_write2st64_b32 v234, v134, v135 offset0:10 offset1:11
    ds_read_b128 v[148:151], v29 offset:2048
    s_add_u32 s83, s86, 0
    s_waitcnt lgkmcnt(7)
    buffer_store_dwordx4 v[144:147], v28, s[28:31], s83 offen sc0 sc1
    v_mfma_f32_32x32x16_bf16 v[32:47], v[168:171], v[72:75], v[32:47]
    v_mfma_f32_32x32x16_bf16 v[48:63], v[168:171], v[104:107], v[48:63]
    ds_read_b64_tr_b16 v[84:85], v6 offset:53248
    ds_read_b64_tr_b16 v[86:87], v6 offset:54272
    ds_read_b64_tr_b16 v[116:117], v7 offset:53248
    ds_read_b64_tr_b16 v[118:119], v7 offset:54272
    v_mul_f32 v136, s76, v136
    v_mul_f32 v152, s76, v152
    v_mul_f32 v137, s76, v137
    v_mul_f32 v153, s76, v153
    v_cvt_pk_bf16_f32 v136, v136, v152
    v_cvt_pk_bf16_f32 v137, v137, v153
    ds_write2st64_b32 v234, v136, v137 offset0:16 offset1:17
    v_mul_f32 v138, s76, v138
    v_mul_f32 v154, s76, v154
    v_mul_f32 v139, s76, v139
    v_mul_f32 v155, s76, v155
    v_cvt_pk_bf16_f32 v138, v138, v154
    v_cvt_pk_bf16_f32 v139, v139, v155
    ds_write2st64_b32 v234, v138, v139 offset0:18 offset1:19
    ds_read_b128 v[152:155], v29 offset:4096
    s_add_u32 s83, s86, 2048
    s_waitcnt lgkmcnt(7)
    buffer_store_dwordx4 v[148:151], v28, s[28:31], s83 offen sc0 sc1
    v_mfma_f32_32x32x16_bf16 v[32:47], v[172:175], v[76:79], v[32:47]
    v_mfma_f32_32x32x16_bf16 v[48:63], v[172:175], v[108:111], v[48:63]
    ds_read_b64_tr_b16 v[88:89], v6 offset:57344
    ds_read_b64_tr_b16 v[90:91], v6 offset:58368
    ds_read_b64_tr_b16 v[120:121], v7 offset:57344
    ds_read_b64_tr_b16 v[122:123], v7 offset:58368
    s_add_u32 s83, s86, 4096
    s_waitcnt lgkmcnt(4)
    buffer_store_dwordx4 v[152:155], v28, s[28:31], s83 offen sc0 sc1
    v_mfma_f32_32x32x16_bf16 v[32:47], v[176:179], v[80:83], v[32:47]
    v_mfma_f32_32x32x16_bf16 v[48:63], v[176:179], v[112:115], v[48:63]
    ds_read_b64_tr_b16 v[92:93], v6 offset:61440
    ds_read_b64_tr_b16 v[94:95], v6 offset:62464
    ds_read_b64_tr_b16 v[124:125], v7 offset:61440
    ds_read_b64_tr_b16 v[126:127], v7 offset:62464
    s_cmp_ge_u32 s3, 2
    s_cbranch_scc1 QG3
    s_waitcnt lgkmcnt(8)
    v_mul_f32 v140, s76, v140
    v_mul_f32 v156, s76, v156
    v_mul_f32 v141, s76, v141
    v_mul_f32 v157, s76, v157
    v_cvt_pk_bf16_f32 v140, v140, v156
    v_cvt_pk_bf16_f32 v141, v141, v157
    ds_write2st64_b32 v234, v140, v141 offset0:24 offset1:25
    v_mul_f32 v142, s76, v142
    v_mul_f32 v158, s76, v158
    v_mul_f32 v143, s76, v143
    v_mul_f32 v159, s76, v159
    v_cvt_pk_bf16_f32 v142, v142, v158
    v_cvt_pk_bf16_f32 v143, v143, v159
    ds_write2st64_b32 v234, v142, v143 offset0:26 offset1:27
    ds_read_b128 v[156:159], v29 offset:6144
    s_add_u32 s83, s86, 6144
    s_waitcnt lgkmcnt(0)
    buffer_store_dwordx4 v[156:159], v28, s[28:31], s83 offen sc0 sc1
QG3:
    v_mfma_f32_32x32x16_bf16 v[32:47], v[180:183], v[84:87], v[32:47]
    v_mfma_f32_32x32x16_bf16 v[48:63], v[180:183], v[116:119], v[48:63]
    s_waitcnt lgkmcnt(4)
    v_mfma_f32_32x32x16_bf16 v[32:47], v[184:187], v[88:91], v[32:47]
    v_mfma_f32_32x32x16_bf16 v[48:63], v[184:187], v[120:123], v[48:63]
    s_waitcnt lgkmcnt(0)
    v_mfma_f32_32x32x16_bf16 v[32:47], v[188:191], v[92:95], v[32:47]
    v_mfma_f32_32x32x16_bf16 v[48:63], v[188:191], v[124:127], v[48:63]
    s_mov_b32 s28, s24
    s_mov_b32 s29, s25
    s_mov_b32 s30, 6400000
    s_mov_b32 s31, 0x20000
    s_add_u32 s44, s24, 10485760
    s_addc_u32 s45, s25, 0
    s_mov_b32 s46, 400000
    s_mov_b32 s47, 0x20000
    s_lshl_b32 s82, s27, 8
    s_lshl_b32 s83, s84, 8
    s_add_u32 s48, s20, s82
    s_addc_u32 s49, s21, 0
    s_mov_b32 s50, s83
    s_mov_b32 s51, 0x20000
    s_cmp_lg_u32 s3, 7
    s_cbranch_scc1 X5B
    s_mov_b64 exec, 0xffff
    s_mov_b32 s83, 2097152
    s_waitcnt vmcnt(3)
    s_branch POLLC0
POLL0:
    s_waitcnt vmcnt(0)
POLLC0:
    v_cmp_ne_u32 vcc, 16, v25
    s_nop 0
    s_cmp_eq_u64 vcc, 0
    s_cbranch_scc1 POLLD0
    buffer_load_dword v25, v24, s[52:55], s0 offen sc1
    s_sub_u32 s83, s83, 1
    s_cbranch_scc0 POLL0
    s_waitcnt vmcnt(0)
POLLD0:
    s_mov_b64 exec, -1
X5B:
    v_lshrrev_b32 v237, 1, v0
    v_lshlrev_b32 v238, 4, v237
    s_lshr_b32 s82, s26, 2
    s_lshl_b32 s82, s82, 12
    s_and_b32 s83, s26, 3
    s_lshl_b32 s83, s83, 2
    s_add_u32 s82, s82, s83
    s_barrier
    buffer_load_dword v20, v238, s[56:59], s82 offen sc1
    s_lshl_b32 s82, s3, 12
    s_add_u32 m0, s82, 28672
    s_add_u32 s83, s82, 32768
    buffer_load_dwordx4 v235, s[36:39], s83 offen lds
    s_add_u32 m0, s82, 29696
    s_add_u32 s83, s82, 33792
    buffer_load_dwordx4 v235, s[36:39], s83 offen lds
    s_add_u32 m0, s82, 30720
    s_add_u32 s83, s82, 34816
    buffer_load_dwordx4 v235, s[36:39], s83 offen lds
    s_add_u32 m0, s82, 31744
    s_add_u32 s83, s82, 35840
    buffer_load_dwordx4 v235, s[36:39], s83 offen lds
    v_pk_mul_f32 v[32:33], v[32:33], s[76:77]
    v_pk_mul_f32 v[48:49], v[48:49], s[76:77]
    v_cvt_pk_bf16_f32 v32, v32, v48
    v_cvt_pk_bf16_f32 v33, v33, v49
    ds_write2st64_b32 v234, v32, v33 offset0:0 offset1:1
    v_pk_mul_f32 v[34:35], v[34:35], s[76:77]
    v_pk_mul_f32 v[50:51], v[50:51], s[76:77]
    v_cvt_pk_bf16_f32 v34, v34, v50
    v_cvt_pk_bf16_f32 v35, v35, v51
    ds_write2st64_b32 v234, v34, v35 offset0:2 offset1:3
    v_pk_mul_f32 v[36:37], v[36:37], s[76:77]
    v_pk_mul_f32 v[52:53], v[52:53], s[76:77]
    v_cvt_pk_bf16_f32 v36, v36, v52
    v_cvt_pk_bf16_f32 v37, v37, v53
    ds_write2st64_b32 v234, v36, v37 offset0:8 offset1:9
    v_pk_mul_f32 v[38:39], v[38:39], s[76:77]
    v_pk_mul_f32 v[54:55], v[54:55], s[76:77]
    v_cvt_pk_bf16_f32 v38, v38, v54
    v_cvt_pk_bf16_f32 v39, v39, v55
    ds_write2st64_b32 v234, v38, v39 offset0:10 offset1:11
    v_pk_mul_f32 v[40:41], v[40:41], s[76:77]
    v_pk_mul_f32 v[56:57], v[56:57], s[76:77]
    v_cvt_pk_bf16_f32 v40, v40, v56
    v_cvt_pk_bf16_f32 v41, v41, v57
    ds_write2st64_b32 v234, v40, v41 offset0:16 offset1:17
    v_pk_mul_f32 v[42:43], v[42:43], s[76:77]
    v_pk_mul_f32 v[58:59], v[58:59], s[76:77]
    v_cvt_pk_bf16_f32 v42, v42, v58
    v_cvt_pk_bf16_f32 v43, v43, v59
    ds_write2st64_b32 v234, v42, v43 offset0:18 offset1:19
    s_cmp_ge_u32 s3, 2
    s_cbranch_scc1 PWD
    v_pk_mul_f32 v[44:45], v[44:45], s[76:77]
    v_pk_mul_f32 v[60:61], v[60:61], s[76:77]
    v_cvt_pk_bf16_f32 v44, v44, v60
    v_cvt_pk_bf16_f32 v45, v45, v61
    ds_write2st64_b32 v234, v44, v45 offset0:24 offset1:25
    v_pk_mul_f32 v[46:47], v[46:47], s[76:77]
    v_pk_mul_f32 v[62:63], v[62:63], s[76:77]
    v_cvt_pk_bf16_f32 v46, v46, v62
    v_cvt_pk_bf16_f32 v47, v47, v63
    ds_write2st64_b32 v234, v46, v47 offset0:26 offset1:27
PWD:
    s_cmp_lg_u32 s3, 6
    s_cbranch_scc1 X7
    s_mov_b32 m0, 2816
    s_mov_b32 s83, 99328
    s_mov_b64 exec, 0xffff
    buffer_load_dwordx4 v235, s[36:39], s83 offen lds
    s_mov_b64 exec, -1
    s_mov_b32 m0, 61440
    s_mov_b32 s83, 98304
    buffer_load_dwordx4 v235, s[36:39], s83 offen lds
    s_waitcnt vmcnt(6)
    s_branch X7B
X7:
    s_waitcnt vmcnt(4)
X7B:
    s_movk_i32 s82, 1568
    v_mul_u32_u24 v237, s82, v237
    v_and_b32 v24, 1, v0
    v_lshlrev_b32 v24, 1, v24
    v_lshrrev_b32 v26, 16, v20
    v_sub_u32 v21, v26, v24
    v_and_b32 v25, 0xffff, v20
    v_add3_u32 v25, v25, v24, v237
    v_lshlrev_b32 v25, 3, v25
    v_cmp_lt_u32 s[80:81], 24, v26
    s_waitcnt lgkmcnt(0)
    v_cmpx_lt_i32 vcc, 0, v21
    s_cbranch_execz RL_0
    buffer_load_dwordx4 v[128:131], v25, s[32:35], 0 offen offset:0
    v_cmpx_lt_i32 vcc, 4, v21
    s_cbranch_execz RL_1
    buffer_load_dwordx4 v[132:135], v25, s[32:35], 0 offen offset:32
    v_cmpx_lt_i32 vcc, 8, v21
    s_cbranch_execz RL_2
    buffer_load_dwordx4 v[136:139], v25, s[32:35], 0 offen offset:64
    v_cmpx_lt_i32 vcc, 12, v21
    s_cbranch_execz RL_3
    buffer_load_dwordx4 v[140:143], v25, s[32:35], 0 offen offset:96
    v_cmpx_lt_i32 vcc, 16, v21
    s_cbranch_execz RL_4
    buffer_load_dwordx4 v[144:147], v25, s[32:35], 0 offen offset:128
    v_cmpx_lt_i32 vcc, 20, v21
    s_cbranch_execz RL_5
    buffer_load_dwordx4 v[148:151], v25, s[32:35], 0 offen offset:160
RL_6:
    s_waitcnt vmcnt(6)
    s_branch RL_DONE
RL_5:
    s_waitcnt vmcnt(5)
    s_branch RL_DONE
RL_4:
    s_waitcnt vmcnt(4)
    s_branch RL_DONE
RL_3:
    s_waitcnt vmcnt(3)
    s_branch RL_DONE
RL_2:
    s_waitcnt vmcnt(2)
    s_branch RL_DONE
RL_1:
    s_waitcnt vmcnt(1)
    s_branch RL_DONE
RL_0:
    s_waitcnt vmcnt(0)
RL_DONE:
    s_mov_b64 exec, -1
    s_cmp_eq_u64 s[80:81], 0
    s_cbranch_scc1 NOLONG
    v_mov_b32 v24, 0
    v_mov_b32 v25, 1
    ds_write_b32 v24, v25 offset:2648
NOLONG:
    s_barrier
    s_cmp_lg_u32 s3, 7
    s_cbranch_scc1 X6
    s_and_b32 s82, s2, 15
    s_lshl_b32 s82, s82, 8
    s_add_u32 s82, s82, 4096
    s_mov_b64 exec, 1
    v_mov_b32 v24, s82
    v_mov_b32 v25, 1
    buffer_atomic_add v25, v24, s[52:55], 0 offen sc1
    s_mov_b64 exec, -1
X6:
    s_and_b32 s82, s26, 31
    s_lshl_b32 s82, s82, 3
    s_add_u32 s82, s82, s3
    s_mul_i32 s83, s82, 1664
    v_lshl_add_u32 v7, v1, 7, s83
    s_mov_b64 exec, 0x1fff
    buffer_load_dword v2, v7, s[44:47], 0 offen sc1
    s_mov_b64 exec, -1
    ds_read_b128 v[28:31], v235 offset:61440
    ds_read_b128 v[64:67], v12 offset:0
    ds_read_b128 v[96:99], v12 offset:8192
    ds_read_b128 v[68:71], v12 offset:1024
    ds_read_b128 v[100:103], v12 offset:9216
    ds_read_b128 v[72:75], v12 offset:2048
    ds_read_b128 v[104:107], v12 offset:10240
    ds_read_b128 v[76:79], v12 offset:3072
    ds_read_b128 v[108:111], v12 offset:11264
    s_waitcnt lgkmcnt(6)
    v_mfma_f32_32x32x16_bf16 v[32:47], v[160:163], v[64:67], 0
    v_mfma_f32_32x32x16_bf16 v[48:63], v[160:163], v[96:99], 0
    ds_read_b128 v[80:83], v12 offset:4096
    ds_read_b128 v[112:115], v12 offset:12288
    s_waitcnt lgkmcnt(6)
    v_mfma_f32_32x32x16_bf16 v[32:47], v[164:167], v[68:71], v[32:47]
    v_mfma_f32_32x32x16_bf16 v[48:63], v[164:167], v[100:103], v[48:63]
    ds_read_b128 v[84:87], v12 offset:5120
    ds_read_b128 v[116:119], v12 offset:13312
    s_waitcnt lgkmcnt(6)
    v_mfma_f32_32x32x16_bf16 v[32:47], v[168:171], v[72:75], v[32:47]
    v_mfma_f32_32x32x16_bf16 v[48:63], v[168:171], v[104:107], v[48:63]
    ds_read_b128 v[88:91], v12 offset:6144
    ds_read_b128 v[120:123], v12 offset:14336
    s_waitcnt lgkmcnt(6)
    v_mfma_f32_32x32x16_bf16 v[32:47], v[172:175], v[76:79], v[32:47]
    v_mfma_f32_32x32x16_bf16 v[48:63], v[172:175], v[108:111], v[48:63]
    ds_read_b128 v[92:95], v12 offset:7168
    ds_read_b128 v[124:127], v12 offset:15360
    s_waitcnt lgkmcnt(6)
    v_mfma_f32_32x32x16_bf16 v[32:47], v[176:179], v[80:83], v[32:47]
    v_mfma_f32_32x32x16_bf16 v[48:63], v[176:179], v[112:115], v[48:63]
    s_waitcnt lgkmcnt(4)
    v_mfma_f32_32x32x16_bf16 v[32:47], v[180:183], v[84:87], v[32:47]
    v_mfma_f32_32x32x16_bf16 v[48:63], v[180:183], v[116:119], v[48:63]
    s_waitcnt lgkmcnt(2)
    v_mfma_f32_32x32x16_bf16 v[32:47], v[184:187], v[88:91], v[32:47]
    v_mfma_f32_32x32x16_bf16 v[48:63], v[184:187], v[120:123], v[48:63]
    s_waitcnt lgkmcnt(0)
    v_mfma_f32_32x32x16_bf16 v[32:47], v[188:191], v[92:95], v[32:47]
    v_mfma_f32_32x32x16_bf16 v[48:63], v[188:191], v[124:127], v[48:63]
    v_mov_b32 v194, v28
    v_mov_b32 v198, v29
    v_mov_b32 v202, v30
    v_mov_b32 v206, v31
    s_cmp_lg_u32 s3, 7
    s_cbranch_scc1 X6B
    s_waitcnt vmcnt(2)
    s_branch X6C
X6B:
    s_waitcnt vmcnt(1)
X6C:
    v_mov_b32 v23, 1
    v_cmpx_lt_i32 vcc, 0, v21
    v_and_b32 v244, 0x1fc, v128
    ds_add_rtn_u32 v152, v244, v23 offset:1568
    v_cmpx_lt_i32 vcc, 1, v21
    v_and_b32 v245, 0x1fc, v130
    ds_add_rtn_u32 v153, v245, v23 offset:1568
    v_cmpx_lt_i32 vcc, 4, v21
    v_and_b32 v246, 0x1fc, v132
    ds_add_rtn_u32 v154, v246, v23 offset:1568
    v_cmpx_lt_i32 vcc, 5, v21
    v_and_b32 v247, 0x1fc, v134
    ds_add_rtn_u32 v155, v247, v23 offset:1568
    v_cmpx_lt_i32 vcc, 8, v21
    s_cbranch_execz H_F
    v_and_b32 v248, 0x1fc, v136
    ds_add_rtn_u32 v156, v248, v23 offset:1568
    v_cmpx_lt_i32 vcc, 9, v21
    v_and_b32 v249, 0x1fc, v138
    ds_add_rtn_u32 v157, v249, v23 offset:1568
    v_cmpx_lt_i32 vcc, 12, v21
    s_cbranch_execz H_F
    v_and_b32 v250, 0x1fc, v140
    ds_add_rtn_u32 v158, v250, v23 offset:1568
    v_cmpx_lt_i32 vcc, 13, v21
    v_and_b32 v251, 0x1fc, v142
    ds_add_rtn_u32 v159, v251, v23 offset:1568
    v_cmpx_lt_i32 vcc, 16, v21
    s_cbranch_execz H_F
    v_and_b32 v252, 0x1fc, v144
    ds_add_rtn_u32 v240, v252, v23 offset:1568
    v_cmpx_lt_i32 vcc, 17, v21
    v_and_b32 v253, 0x1fc, v146
    ds_add_rtn_u32 v241, v253, v23 offset:1568
    v_cmpx_lt_i32 vcc, 20, v21
    s_cbranch_execz H_F
    v_and_b32 v254, 0x1fc, v148
    ds_add_rtn_u32 v242, v254, v23 offset:1568
    v_cmpx_lt_i32 vcc, 21, v21
    v_and_b32 v255, 0x1fc, v150
    ds_add_rtn_u32 v243, v255, v23 offset:1568
H_F:
    s_mov_b64 exec, -1
    v_lshrrev_b32 v31, 1, v235
    v_add_u32 v31, 1568, v31
    s_cmp_lg_u32 s3, 7
    s_cbranch_scc1 X9
    v_lshlrev_b32 v24, 4, v235
    s_movk_i32 s0, 4096
    s_mov_b64 exec, 0xffff
    buffer_load_dword v25, v24, s[52:55], s0 offen sc1
    s_mov_b64 exec, -1
X9:
    s_and_b32 s82, s26, 31
    s_lshl_b32 s82, s82, 3
    s_add_u32 s82, s82, s3
    s_mul_i32 s83, s82, 4096
    s_add_u32 s83, s83, 0
    s_mov_b64 exec, -1
    v_lshl_add_u32 v6, v1, 7, s83
    s_mov_b64 exec, 0xffffffff
    buffer_load_dword v2, v6, s[28:31], 0 offen sc1
    s_mov_b64 exec, -1
X9B:
    s_waitcnt lgkmcnt(0)
    s_barrier
    ds_read_b64 v[26:27], v31
    v_mov_b32 v30, 0
    ds_read_b32 v30, v30 offset:2648
    v_pk_mul_f32 v[32:33], v[32:33], s[76:77]
    v_pk_mul_f32 v[34:35], v[34:35], s[76:77]
    v_pk_mul_f32 v[36:37], v[36:37], s[76:77]
    v_pk_mul_f32 v[38:39], v[38:39], s[76:77]
    v_pk_mul_f32 v[40:41], v[40:41], s[76:77]
    v_pk_mul_f32 v[42:43], v[42:43], s[76:77]
    v_pk_mul_f32 v[44:45], v[44:45], s[76:77]
    v_pk_mul_f32 v[46:47], v[46:47], s[76:77]
    v_pk_mul_f32 v[48:49], v[48:49], s[76:77]
    v_pk_mul_f32 v[50:51], v[50:51], s[76:77]
    v_pk_mul_f32 v[52:53], v[52:53], s[76:77]
    v_pk_mul_f32 v[54:55], v[54:55], s[76:77]
    v_pk_mul_f32 v[56:57], v[56:57], s[76:77]
    v_pk_mul_f32 v[58:59], v[58:59], s[76:77]
    v_pk_mul_f32 v[60:61], v[60:61], s[76:77]
    v_pk_mul_f32 v[62:63], v[62:63], s[76:77]
    s_waitcnt lgkmcnt(0)
    v_add_u32 v28, v26, v27
    v_mov_b32 v29, v28
    v_readfirstlane_b32 s64, v30
    s_nop 0
    v_add_u32_dpp v29, v29, v29 row_shr:1 row_mask:0xf bank_mask:0xf bound_ctrl:1
    s_nop 1
    v_add_u32_dpp v29, v29, v29 row_shr:2 row_mask:0xf bank_mask:0xf bound_ctrl:1
    s_nop 1
    v_add_u32_dpp v29, v29, v29 row_shr:4 row_mask:0xf bank_mask:0xf bound_ctrl:1
    s_nop 1
    v_add_u32_dpp v29, v29, v29 row_shr:8 row_mask:0xf bank_mask:0xf bound_ctrl:1
    s_nop 1
    v_add_u32_dpp v29, v29, v29 row_bcast:15 row_mask:0xa bank_mask:0xf
    s_nop 1
    v_add_u32_dpp v29, v29, v29 row_bcast:31 row_mask:0xc bank_mask:0xf
    v_subrev_u32 v28, 18462, v28
    v_sub_u32 v238, v29, v28
    v_add_u32 v239, v238, v26
    v_readlane_b32 s12, v29, 63
    ds_write_b64 v31, v[238:239] offset:512
    v_cmpx_lt_i32 vcc, 0, v21
    ds_read_b32 v244, v244 offset:2080
    v_cmpx_lt_i32 vcc, 1, v21
    ds_read_b32 v245, v245 offset:2080
    v_cmpx_lt_i32 vcc, 4, v21
    ds_read_b32 v246, v246 offset:2080
    v_cmpx_lt_i32 vcc, 5, v21
    ds_read_b32 v247, v247 offset:2080
    v_cmpx_lt_i32 vcc, 8, v21
    s_cbranch_execz SC1_F
    ds_read_b32 v248, v248 offset:2080
    v_cmpx_lt_i32 vcc, 9, v21
    ds_read_b32 v249, v249 offset:2080
    v_cmpx_lt_i32 vcc, 12, v21
    s_cbranch_execz SC1_F
    ds_read_b32 v250, v250 offset:2080
    v_cmpx_lt_i32 vcc, 13, v21
    ds_read_b32 v251, v251 offset:2080
    v_cmpx_lt_i32 vcc, 16, v21
    s_cbranch_execz SC1_F
    ds_read_b32 v252, v252 offset:2080
    v_cmpx_lt_i32 vcc, 17, v21
    ds_read_b32 v253, v253 offset:2080
    v_cmpx_lt_i32 vcc, 20, v21
    s_cbranch_execz SC1_F
    ds_read_b32 v254, v254 offset:2080
    v_cmpx_lt_i32 vcc, 21, v21
    ds_read_b32 v255, v255 offset:2080
SC1_F:
    s_mov_b64 exec, -1
    s_add_u32 s82, s12, 7
    s_lshr_b32 s82, s82, 3
    s_lshr_b32 s60, s82, 2
    s_and_b32 s61, s82, 3
    s_add_u32 s82, s60, 7
    s_lshr_b32 s82, s82, 3
    s_lshl_b32 s82, s82, 2
    s_min_u32 s62, s82, s60
    s_add_u32 s82, s60, 8
    s_lshr_b32 s82, s82, 3
    s_lshl_b32 s82, s82, 2
    s_add_u32 s83, s60, 1
    s_min_u32 s15, s82, s83
    s_mov_b32 s14, 0
    s_and_b32 s18, s3, 3
    s_cmp_lt_u32 s3, 4
    s_cbranch_scc1 SPLA
    s_sub_u32 s82, s15, s62
    s_mul_i32 s82, s82, s61
    s_lshl_b32 s14, s62, 2
    s_add_u32 s14, s14, s82
    s_mov_b32 s75, s14
    s_sub_u32 s62, s60, s62
    s_sub_u32 s15, s83, s15
SPLA:
    s_mul_i32 s82, s18, s62
    s_add_u32 s14, s14, s82
    s_min_u32 s82, s18, s61
    s_sub_u32 s83, s15, s62
    s_mul_i32 s82, s82, s83
    s_add_u32 s14, s14, s82
    s_cmp_lt_u32 s18, s61
    s_cselect_b32 s70, s15, s62
    s_add_u32 s13, s70, 3
    s_lshr_b32 s13, s13, 2
    s_add_u32 s70, s70, 3
    s_and_b32 s70, s70, 3
    s_lshl_b32 s74, s70, 3
    s_add_u32 s74, s74, 7
    s_sub_u32 s82, 31, s74
    s_lshr_b32 s72, -1, s82
    s_mov_b32 s73, 0
    s_cmp_eq_u32 s13, 1
    s_cselect_b32 s10, s72, -1
    s_cselect_b32 s71, s74, 31
    s_lshl_b32 s82, s14, 6
    s_add_u32 s82, s82, 147696
    v_and_b32 v8, 31, v1
    v_lshl_add_u32 v8, v8, 3, s82
    v_and_b32 v9, 0x38, v1
    v_add3_u32 v9, v9, s82, 4
    s_cmp_gt_u32 s12, 1984
    s_cselect_b32 s64, 1, s64
    s_waitcnt lgkmcnt(0)
    s_cbranch_scc1 NOSC2
    v_cmpx_lt_i32 vcc, 0, v21
    v_add_lshl_u32 v244, v244, v152, 3
    ds_write_b64 v244, v[128:129]
    v_cmpx_lt_i32 vcc, 1, v21
    v_add_lshl_u32 v245, v245, v153, 3
    ds_write_b64 v245, v[130:131]
    v_cmpx_lt_i32 vcc, 4, v21
    v_add_lshl_u32 v246, v246, v154, 3
    ds_write_b64 v246, v[132:133]
    v_cmpx_lt_i32 vcc, 5, v21
    v_add_lshl_u32 v247, v247, v155, 3
    ds_write_b64 v247, v[134:135]
    v_cmpx_lt_i32 vcc, 8, v21
    s_cbranch_execz SC2_F
    v_add_lshl_u32 v248, v248, v156, 3
    ds_write_b64 v248, v[136:137]
    v_cmpx_lt_i32 vcc, 9, v21
    v_add_lshl_u32 v249, v249, v157, 3
    ds_write_b64 v249, v[138:139]
    v_cmpx_lt_i32 vcc, 12, v21
    s_cbranch_execz SC2_F
    v_add_lshl_u32 v250, v250, v158, 3
    ds_write_b64 v250, v[140:141]
    v_cmpx_lt_i32 vcc, 13, v21
    v_add_lshl_u32 v251, v251, v159, 3
    ds_write_b64 v251, v[142:143]
    v_cmpx_lt_i32 vcc, 16, v21
    s_cbranch_execz SC2_F
    v_add_lshl_u32 v252, v252, v240, 3
    ds_write_b64 v252, v[144:145]
    v_cmpx_lt_i32 vcc, 17, v21
    v_add_lshl_u32 v253, v253, v241, 3
    ds_write_b64 v253, v[146:147]
    v_cmpx_lt_i32 vcc, 20, v21
    s_cbranch_execz SC2_F
    v_add_lshl_u32 v254, v254, v242, 3
    ds_write_b64 v254, v[148:149]
    v_cmpx_lt_i32 vcc, 21, v21
    v_add_lshl_u32 v255, v255, v243, 3
    ds_write_b64 v255, v[150:151]
SC2_F:
    s_mov_b64 exec, -1
NOSC2:
    s_min_u32 s12, s12, 1984
    s_cmp_lg_u32 s3, 6
    s_cbranch_scc1 NOCHK
    ds_read_b64 v[236:237], v31 offset:544
    v_cmp_lt_u32 vcc, 0, v26
    v_cmp_lt_u32 s[80:81], 0, v27
    s_flbit_i32_b64 s82, vcc
    s_flbit_i32_b64 s83, s[80:81]
    s_lshl_b32 s82, s82, 1
    s_lshl_b32 s83, s83, 1
    s_add_u32 s82, s82, 1
    s_min_u32 s82, s82, s83
    s_sub_u32 s17, 127, s82
    v_subrev_u32 v239, 18463, v239
    v_add_u32 v29, -1, v29
    s_waitcnt lgkmcnt(0)
    v_subrev_u32 v236, 18462, v236
    v_subrev_u32 v237, 18462, v237
    v_cmp_gt_u32 vcc, s12, v236
    v_cmp_gt_u32 s[80:81], s12, v237
    v_cmp_le_i32 s[6:7], 0, v239
    v_cmp_le_i32 s[4:5], 0, v29
    v_sub_u32 v239, v236, v239
    v_sub_u32 v29, v237, v29
    s_and_b64 vcc, vcc, s[6:7]
    s_and_b64 s[80:81], s[80:81], s[4:5]
    v_cmp_gt_u32 s[6:7], 32, v239
    v_cmp_gt_u32 s[4:5], 32, v29
    s_and_b64 vcc, vcc, s[6:7]
    s_and_b64 s[80:81], s[80:81], s[4:5]
    s_or_b64 vcc, vcc, s[80:81]
    s_and_b32 vcc_hi, vcc_hi, 0x0fffffff
    s_cmp_lg_u64 vcc, 0
    s_cselect_b32 s82, 1, s64
    v_mov_b32 v26, 0
    v_mov_b32 v27, s82
    ds_write_b32 v26, v27 offset:2652
    s_add_u32 s82, s12, 32
    v_add_u32 v24, s12, v1
    s_lshl_b32 s83, s17, 3
    s_or_b32 s83, s83, s16
    v_cmpx_gt_u32 vcc, s82, v24
    v_mov_b32 v27, s83
    v_add_u32 v24, 18462, v24
    v_lshlrev_b32 v24, 3, v24
    ds_write_b64 v24, v[26:27]
    s_mov_b64 exec, -1
NOCHK:
    s_cmp_lg_u32 s3, 7
    s_cbranch_scc1 X8
    s_mov_b64 exec, 0xffff
    s_mov_b32 s83, 2097152
    s_waitcnt vmcnt(1)
    s_branch POLLC1
POLL1:
    s_waitcnt vmcnt(0)
POLLC1:
    v_cmp_ne_u32 vcc, 16, v25
    s_nop 0
    s_cmp_eq_u64 vcc, 0
    s_cbranch_scc1 POLLD1
    buffer_load_dword v25, v24, s[52:55], s0 offen sc1
    s_sub_u32 s83, s83, 1
    s_cbranch_scc0 POLL1
    s_waitcnt vmcnt(0)
POLLD1:
    s_mov_b64 exec, -1
X8:
    s_mul_i32 s82, s27, 6
    s_add_u32 s82, s82, 6400000
    s_add_u32 s52, s20, s82
    s_addc_u32 s53, s21, 0
    s_mov_b32 s54, 1024
    s_mov_b32 s55, 0x20000
    v_mov_b32 v30, 0
    s_waitcnt lgkmcnt(0)
    s_barrier
    ds_read_b32 v30, v30 offset:2652
FIRST:
    s_cmp_eq_u32 s64, 0
    s_cselect_b32 s20, 1, 0
    ds_read_b64 v[144:145], v8
    ds_read2_b32 v[248:249], v9 offset0:0 offset1:16
    ds_read2_b32 v[250:251], v9 offset0:32 offset1:48
    ds_read_b64 v[20:21], v8 offset:256
    ds_read2_b32 v[152:153], v9 offset0:64 offset1:80
    ds_read2_b32 v[154:155], v9 offset0:96 offset1:112
    s_setprio 1
    s_cmp_ge_u32 s3, 4
    s_cbranch_scc1 NOPRIO
    s_setprio 2
NOPRIO:
    s_waitcnt lgkmcnt(6)
    v_readfirstlane_b32 s82, v30
    s_nop 0
    s_cmp_lg_u32 s82, 0
    s_cbranch_scc1 SLOW_ENTRY
    s_cmp_eq_u32 s13, 0
    s_cbranch_scc1 EMPTY_WAVE
    s_mov_b32 s30, 6400000
    s_mov_b32 s46, 400000
    v_add_u32 v8, 0x200, v8
    v_add_u32 v9, 0x200, v9
    s_waitcnt lgkmcnt(3)
    v_lshrrev_b32 v24, 12, v145
    v_mad_u32_u16 v248, v248, s66, v5 op_sel:[1,0,0,0]
    v_mad_u32_u16 v249, v249, s66, v5 op_sel:[1,0,0,0]
    v_mad_u32_u16 v250, v250, s66, v5 op_sel:[1,0,0,0]
    v_mad_u32_u16 v251, v251, s66, v5 op_sel:[1,0,0,0]
    buffer_load_dwordx3 v[148:150], v24, s[44:47], 0 offen
    s_add_u32 m0, s87, 0
    s_nop 0
    buffer_load_dwordx4 v248, s[28:31], 0 offen offset:0 lds
    s_add_u32 m0, s87, 1024
    s_nop 0
    buffer_load_dwordx4 v249, s[28:31], 0 offen offset:0 lds
    s_add_u32 m0, s87, 2048
    s_nop 0
    buffer_load_dwordx4 v250, s[28:31], 0 offen offset:0 lds
    s_add_u32 m0, s87, 3072
    s_nop 0
    buffer_load_dwordx4 v251, s[28:31], 0 offen offset:0 lds
    s_lshl_b32 s82, s3, 11
    v_add_u32 v24, s82, v235
    v_mov_b32 v28, 0
    v_mov_b32 v29, 0
    v_mov_b32 v30, 0
    v_mov_b32 v31, 0
    ds_write_b128 v24, v[28:31] offset:3072
    ds_write_b128 v24, v[28:31] offset:4096
    v_readlane_b32 s62, v145, 0
    v_readlane_b32 s15, v145, s71
    v_bitop3_b32 v12, v145, 56, v11 bitop3:0x6a
    v_cmp_gt_u32 s[4:5], s16, v145
    s_bfe_u32 s18, s62, 0x70003
    s_bfe_u32 s69, s15, 0x70003
    s_min_u32 s17, s18, 90
    v_subrev_u32 v236, s17, v15
    v_and_b32 v236, 7, v236
    v_add_u32 v236, s17, v236
    v_lshl_add_u32 v236, v236, 8, v16
    ds_read_b64_tr_b16 v[192:193], v236 offset:0
    ds_read_b64_tr_b16 v[196:197], v236 offset:64
    ds_read_b64_tr_b16 v[200:201], v236 offset:128
    ds_read_b64_tr_b16 v[204:205], v236 offset:192
    v_and_or_b32 v23, v145, 56, v10
    v_and_b32 v236, 0x3f8, v145
    ds_read_b64 v[216:217], v23 offset:2688
    ds_read2_b64 v[236:239], v236 offset0:0 offset1:98
    s_add_u32 m0, s87, 3968
    s_nop 0
    buffer_load_dwordx4 v248, s[28:31], 0 offen offset:128 lds
    s_add_u32 m0, s87, 4992
    s_nop 0
    buffer_load_dwordx4 v249, s[28:31], 0 offen offset:128 lds
    s_add_u32 m0, s87, 6016
    s_nop 0
    buffer_load_dwordx4 v250, s[28:31], 0 offen offset:128 lds
    s_add_u32 m0, s87, 7040
    s_nop 0
    buffer_load_dwordx4 v251, s[28:31], 0 offen offset:128 lds
    s_cmp_ge_u32 s13, 2
    s_cselect_b32 s46, 400000, 0
    s_cselect_b32 s30, 6400000, 0
    s_waitcnt lgkmcnt(0)
    v_lshrrev_b32 v24, 12, v21
    v_mad_u32_u16 v248, v152, s66, v5 op_sel:[1,0,0,0]
    v_mad_u32_u16 v249, v153, s66, v5 op_sel:[1,0,0,0]
    v_mad_u32_u16 v250, v154, s66, v5 op_sel:[1,0,0,0]
    v_mad_u32_u16 v251, v155, s66, v5 op_sel:[1,0,0,0]
    s_waitcnt vmcnt(4)
    ds_read_b64_tr_b16 v[184:185], v3 offset:0
    ds_read_b64_tr_b16 v[186:187], v3 offset:512
    ds_read_b64_tr_b16 v[188:189], v3 offset:1024
    ds_read_b64_tr_b16 v[190:191], v3 offset:1536
    ds_read_b64_tr_b16 v[240:241], v4 offset:0
    ds_read_b64_tr_b16 v[242:243], v4 offset:512
    ds_read_b64_tr_b16 v[244:245], v4 offset:1024
    ds_read_b64_tr_b16 v[246:247], v4 offset:1536
    v_sub_f32 v236, v236, v148
    v_sub_f32 v237, v237, v149
    v_sub_f32 v238, v238, v150
    v_mul_f32 v239, v236, v236
    v_cvt_pk_bf16_f32 v220, v236, v237
    v_fmac_f32 v239, v237, v237
    v_cvt_pk_bf16_f32 v221, v238, 1.0
    v_fmac_f32 v239, v238, v238
    v_cvt_pk_bf16_f32 v218, v239, v144
    s_waitcnt lgkmcnt(0)
    s_nop 0
    v_mfma_f32_32x32x16_bf16 v[128:143], v[216:219], v[192:195], 0
    buffer_load_dwordx3 v[0:2], v24, s[44:47], 0 offen
    s_add_u32 m0, s87, 0
    s_nop 0
    buffer_load_dwordx4 v248, s[28:31], 0 offen offset:0 lds
    v_smfmac_f32_32x32x32_bf16 v[128:143], v[208:211], v[184:191], v212
    s_add_u32 m0, s87, 1024
    s_nop 0
    buffer_load_dwordx4 v249, s[28:31], 0 offen offset:0 lds
    s_waitcnt lgkmcnt(0)
    s_nop 7
    v_exp_f32 v160, v128
    v_exp_f32 v161, v129
    s_add_u32 m0, s87, 2048
    s_nop 0
    buffer_load_dwordx4 v250, s[28:31], 0 offen offset:0 lds
    v_exp_f32 v162, v130
    v_mfma_f32_32x32x16_bf16 v[144:159], v[216:219], v[196:199], 0
    s_add_u32 m0, s87, 3072
    s_nop 1
    v_exp_f32 v163, v131
    v_exp_f32 v164, v132
    v_exp_f32 v165, v133
    v_smfmac_f32_32x32x32_bf16 v[144:159], v[208:211], v[240:247], v212
    buffer_load_dwordx4 v251, s[28:31], 0 offen offset:0 lds
    v_exp_f32 v166, v134
    v_exp_f32 v167, v135
    v_exp_f32 v168, v136
    v_exp_f32 v169, v137
    v_exp_f32 v170, v138
    s_and_b64 exec, s[4:5], s[10:11]
    ds_write_b64 v12, v[220:221]
    s_mov_b64 exec, -1
    v_exp_f32 v171, v139
    v_exp_f32 v172, v140
    v_exp_f32 v173, v141
    v_exp_f32 v174, v142
    v_exp_f32 v175, v143
    v_pk_add_f32 v[160:161], v[160:161], 1.0 op_sel_hi:[1,0]
    v_pk_add_f32 v[162:163], v[162:163], 1.0 op_sel_hi:[1,0]
    v_pk_add_f32 v[164:165], v[164:165], 1.0 op_sel_hi:[1,0]
    v_pk_add_f32 v[166:167], v[166:167], 1.0 op_sel_hi:[1,0]
    v_pk_add_f32 v[168:169], v[168:169], 1.0 op_sel_hi:[1,0]
    v_pk_add_f32 v[170:171], v[170:171], 1.0 op_sel_hi:[1,0]
    v_pk_add_f32 v[172:173], v[172:173], 1.0 op_sel_hi:[1,0]
    v_pk_add_f32 v[174:175], v[174:175], 1.0 op_sel_hi:[1,0]
    v_rcp_f32 v160, v160
    v_rcp_f32 v161, v161
    s_waitcnt vmcnt(5)
    v_rcp_f32 v162, v162
    v_rcp_f32 v163, v163
    v_rcp_f32 v164, v164
    v_rcp_f32 v165, v165
    v_rcp_f32 v166, v166
    v_rcp_f32 v167, v167
    ds_read_b64_tr_b16 v[188:189], v3 offset:5120
    ds_read_b64_tr_b16 v[190:191], v3 offset:5632
    v_rcp_f32 v168, v168
    v_rcp_f32 v169, v169
    ds_read_b64_tr_b16 v[24:25], v13
    v_rcp_f32 v170, v170
    v_rcp_f32 v171, v171
    v_rcp_f32 v172, v172
    v_rcp_f32 v173, v173
    v_rcp_f32 v174, v174
    v_rcp_f32 v175, v175
    v_pk_mul_f32 v[160:161], v[160:161], v[128:129]
    ds_read_b64_tr_b16 v[184:185], v3 offset:4096
    ds_read_b64_tr_b16 v[186:187], v3 offset:4608
    ds_read_b64_tr_b16 v[26:27], v14 offset:512
    v_pk_mul_f32 v[162:163], v[162:163], v[130:131]
    v_pk_mul_f32 v[164:165], v[164:165], v[132:133]
    ds_read_b64_tr_b16 v[28:29], v13 offset:1024
    v_pk_mul_f32 v[166:167], v[166:167], v[134:135]
    v_pk_mul_f32 v[168:169], v[168:169], v[136:137]
    v_pk_mul_f32 v[170:171], v[170:171], v[138:139]
    v_pk_mul_f32 v[172:173], v[172:173], v[140:141]
    ds_read_b64_tr_b16 v[240:241], v4 offset:4096
    ds_read_b64_tr_b16 v[242:243], v4 offset:4608
    ds_read_b64_tr_b16 v[244:245], v4 offset:5120
    ds_read_b64_tr_b16 v[246:247], v4 offset:5632
    ds_read_b64_tr_b16 v[30:31], v14 offset:1536
    v_pk_mul_f32 v[174:175], v[174:175], v[142:143]
    v_cvt_pk_bf16_f32 v176, v160, v161
    v_cvt_pk_bf16_f32 v177, v162, v163
    v_cvt_pk_bf16_f32 v178, v164, v165
    s_and_b64 exec, s[4:5], s[10:11]
    ds_write_b64 v12, v[232:233]
    s_mov_b64 exec, -1
    v_cvt_pk_bf16_f32 v179, v166, v167
    v_cvt_pk_bf16_f32 v180, v168, v169
    v_cvt_pk_bf16_f32 v181, v170, v171
    v_cvt_pk_bf16_f32 v182, v172, v173
    v_cvt_pk_bf16_f32 v183, v174, v175
    s_branch BODY_F
FLUSH:
    s_cmp_eq_u32 s13, 0
    s_cbranch_scc1 FP0
    s_setprio 0
FP0:
    s_add_u32 s83, s17, 445
    v_subrev_u32 v237, s17, v18
    v_and_b32 v237, 7, v237
    v_add_u32 v237, s83, v237
    s_waitcnt lgkmcnt(0)
    ds_read_b128 v[160:163], v213 offset:2816
    ds_read_b128 v[164:167], v213 offset:2880
    ds_read_b128 v[168:171], v213 offset:2944
    ds_read_b128 v[172:175], v213 offset:3008
    v_mad_u32_u24 v239, v237, s67, v19
    v_mov_b32 v128, 0
    v_mov_b32 v129, 0
    s_cmp_lg_u32 s20, 0
    s_cbranch_scc1 FL_NEW
    v_subrev_u32 v236, s17, v15
    v_and_b32 v236, 7, v236
    v_add_u32 v236, s83, v236
    v_mad_u32_u24 v236, v236, s67, v17
    ds_read_b64_tr_b16 v[222:223], v236 offset:0
    ds_read_b64_tr_b16 v[224:225], v236 offset:64
    ds_read_b64_tr_b16 v[226:227], v236 offset:128
    ds_read_b64_tr_b16 v[228:229], v236 offset:192
    ds_read_b32 v128, v239
    s_waitcnt lgkmcnt(1)
    v_mfma_f32_32x32x16_bf16 v[64:79], v[222:225], v[230:233], v[64:79]
    v_mfma_f32_32x32x16_bf16 v[80:95], v[224:227], v[230:233], v[80:95]
    v_mfma_f32_32x32x16_bf16 v[96:111], v[226:229], v[230:233], v[96:111]
    v_mfma_f32_32x32x16_bf16 v[112:127], v[228:231], v[230:233], v[112:127]
FL_NEW:
    s_add_u32 s83, s18, 445
    v_subrev_u32 v238, s83, v237
    s_sub_u32 s82, s19, s18
    v_cmp_ge_u32 vcc, s82, v238
    v_mad_u32_u24 v237, v237, s67, v22
    s_mov_b32 s20, 0
    s_mov_b32 s17, s60
    s_mov_b32 s18, s62
    s_and_b64 s[80:81], vcc, s[78:79]
    s_and_b64 s[6:7], vcc, s[8:9]
    v_cvt_pk_bf16_f32 v64, v64, v65
    v_cvt_pk_bf16_f32 v65, v66, v67
    v_cvt_pk_bf16_f32 v66, v68, v69
    v_cvt_pk_bf16_f32 v67, v70, v71
    v_cvt_pk_bf16_f32 v68, v72, v73
    v_cvt_pk_bf16_f32 v69, v74, v75
    v_cvt_pk_bf16_f32 v70, v76, v77
    v_cvt_pk_bf16_f32 v71, v78, v79
    v_cvt_pk_bf16_f32 v80, v80, v81
    v_cvt_pk_bf16_f32 v81, v82, v83
    s_waitcnt lgkmcnt(0)
    v_smfmac_f32_32x32x32_bf16 v[128:143], v[160:163], v[64:71], v214
    v_cvt_pk_bf16_f32 v82, v84, v85
    v_cvt_pk_bf16_f32 v83, v86, v87
    v_cvt_pk_bf16_f32 v84, v88, v89
    v_cvt_pk_bf16_f32 v85, v90, v91
    v_cvt_pk_bf16_f32 v86, v92, v93
    v_cvt_pk_bf16_f32 v87, v94, v95
    v_cvt_pk_bf16_f32 v96, v96, v97
    v_cvt_pk_bf16_f32 v97, v98, v99
    v_smfmac_f32_32x32x32_bf16 v[128:143], v[164:167], v[80:87], v214
    v_cvt_pk_bf16_f32 v98, v100, v101
    v_cvt_pk_bf16_f32 v99, v102, v103
    v_cvt_pk_bf16_f32 v100, v104, v105
    v_cvt_pk_bf16_f32 v101, v106, v107
    v_cvt_pk_bf16_f32 v102, v108, v109
    v_cvt_pk_bf16_f32 v103, v110, v111
    v_cvt_pk_bf16_f32 v112, v112, v113
    v_cvt_pk_bf16_f32 v113, v114, v115
    v_smfmac_f32_32x32x32_bf16 v[128:143], v[168:171], v[96:103], v214
    v_cvt_pk_bf16_f32 v114, v116, v117
    v_cvt_pk_bf16_f32 v115, v118, v119
    v_cvt_pk_bf16_f32 v116, v120, v121
    v_cvt_pk_bf16_f32 v117, v122, v123
    v_cvt_pk_bf16_f32 v118, v124, v125
    v_cvt_pk_bf16_f32 v119, v126, v127
    s_mov_b64 exec, s[80:81]
    ds_write_b128 v237, v[64:67]
    v_smfmac_f32_32x32x32_bf16 v[128:143], v[172:175], v[112:119], v214
    ds_write_b128 v237, v[68:71] offset:32
    ds_write_b128 v237, v[80:83] offset:64
    ds_write_b128 v237, v[84:87] offset:96
    ds_write_b128 v237, v[96:99] offset:128
    ds_write_b128 v237, v[100:103] offset:160
    ds_write_b128 v237, v[112:115] offset:192
    ds_write_b128 v237, v[116:119] offset:224
    s_mov_b64 exec, s[6:7]
    s_nop 3
    v_add_f32 v23, v128, v129
    ds_write_b32 v239, v23
    s_lshl_b32 s82, s3, 2
    s_mov_b64 exec, 1
    v_mov_b32 v236, s82
    v_mov_b32 v237, s63
    ds_write_b32 v236, v237 offset:2656
    s_mov_b64 exec, -1
    s_cmp_eq_u32 s13, 0
    s_cbranch_scc1 WAVE_DONE
    s_cmp_lt_u32 s3, 4
    s_cbranch_scc1 FP1
    s_setprio 1
    s_branch FP2
FP1:
    s_cmp_lt_u32 s13, s68
    s_cbranch_scc1 FP2
    s_setprio 2
FP2:
    s_cmp_lg_u32 s73, 0
    s_cbranch_scc1 PRET
BODY_F:
    s_cmp_gt_u32 s13, s68
    s_cbranch_scc1 KP_F
    s_setprio 0
KP_F:
    s_waitcnt lgkmcnt(0)
    v_exp_f32 v160, v144
    v_exp_f32 v161, v145
    s_add_u32 m0, s87, 3968
    s_nop 0
    buffer_load_dwordx4 v248, s[28:31], 0 offen offset:128 lds
    v_exp_f32 v162, v146
    v_mfma_f32_32x32x16_bf16 v[128:143], v[216:219], v[200:203], 0
    s_add_u32 m0, s87, 4992
    v_exp_f32 v163, v147
    v_exp_f32 v164, v148
    v_exp_f32 v165, v149
    v_smfmac_f32_32x32x32_bf16 v[128:143], v[208:211], v[184:191], v212
    buffer_load_dwordx4 v249, s[28:31], 0 offen offset:128 lds
    v_exp_f32 v166, v150
    v_exp_f32 v167, v151
    v_exp_f32 v168, v152
    v_exp_f32 v169, v153
    v_exp_f32 v170, v154
    v_exp_f32 v171, v155
    v_exp_f32 v172, v156
    v_exp_f32 v173, v157
    v_exp_f32 v174, v158
    v_exp_f32 v175, v159
    v_pk_add_f32 v[160:161], v[160:161], 1.0 op_sel_hi:[1,0]
    v_pk_add_f32 v[162:163], v[162:163], 1.0 op_sel_hi:[1,0]
    v_pk_add_f32 v[164:165], v[164:165], 1.0 op_sel_hi:[1,0]
    v_pk_add_f32 v[166:167], v[166:167], 1.0 op_sel_hi:[1,0]
    v_pk_add_f32 v[168:169], v[168:169], 1.0 op_sel_hi:[1,0]
    v_pk_add_f32 v[170:171], v[170:171], 1.0 op_sel_hi:[1,0]
    v_pk_add_f32 v[172:173], v[172:173], 1.0 op_sel_hi:[1,0]
    v_pk_add_f32 v[174:175], v[174:175], 1.0 op_sel_hi:[1,0]
    v_rcp_f32 v160, v160
    v_rcp_f32 v161, v161
    v_mfma_f32_32x32x16_bf16 v[64:79], v[176:179], v[24:27], 0
    v_rcp_f32 v162, v162
    v_rcp_f32 v163, v163
    v_rcp_f32 v164, v164
    v_rcp_f32 v165, v165
    v_rcp_f32 v166, v166
    v_rcp_f32 v167, v167
    v_rcp_f32 v168, v168
    v_rcp_f32 v169, v169
    v_mfma_f32_32x32x16_bf16 v[64:79], v[180:183], v[28:31], v[64:79]
    v_rcp_f32 v170, v170
    v_rcp_f32 v171, v171
    v_rcp_f32 v172, v172
    v_rcp_f32 v173, v173
    v_rcp_f32 v174, v174
    v_rcp_f32 v175, v175
    v_pk_mul_f32 v[160:161], v[160:161], v[144:145]
    v_pk_mul_f32 v[162:163], v[162:163], v[146:147]
    v_pk_mul_f32 v[164:165], v[164:165], v[148:149]
    v_pk_mul_f32 v[166:167], v[166:167], v[150:151]
    v_pk_mul_f32 v[168:169], v[168:169], v[152:153]
    v_pk_mul_f32 v[170:171], v[170:171], v[154:155]
    v_pk_mul_f32 v[172:173], v[172:173], v[156:157]
    v_pk_mul_f32 v[174:175], v[174:175], v[158:159]
    v_cvt_pk_bf16_f32 v176, v160, v161
    v_cvt_pk_bf16_f32 v177, v162, v163
    v_cvt_pk_bf16_f32 v178, v164, v165
    v_cvt_pk_bf16_f32 v179, v166, v167
    v_cvt_pk_bf16_f32 v180, v168, v169
    v_cvt_pk_bf16_f32 v181, v170, v171
    v_cvt_pk_bf16_f32 v182, v172, v173
    v_cvt_pk_bf16_f32 v183, v174, v175
    s_waitcnt lgkmcnt(0)
    v_exp_f32 v160, v128
    v_exp_f32 v161, v129
    s_add_u32 m0, s87, 6016
    s_nop 0
    buffer_load_dwordx4 v250, s[28:31], 0 offen offset:128 lds
    v_exp_f32 v162, v130
    v_mfma_f32_32x32x16_bf16 v[144:159], v[216:219], v[204:207], 0
    s_add_u32 m0, s87, 7040
    v_exp_f32 v163, v131
    v_exp_f32 v164, v132
    v_exp_f32 v165, v133
    v_smfmac_f32_32x32x32_bf16 v[144:159], v[208:211], v[240:247], v212
    buffer_load_dwordx4 v251, s[28:31], 0 offen offset:128 lds
    v_exp_f32 v166, v134
    v_exp_f32 v167, v135
    v_and_or_b32 v23, v21, 56, v10
    v_and_b32 v236, 0x3f8, v21
    v_exp_f32 v168, v136
    v_exp_f32 v169, v137
    v_exp_f32 v170, v138
    v_exp_f32 v171, v139
    ds_read_b64 v[216:217], v23 offset:2688
    ds_read2_b64 v[236:239], v236 offset0:0 offset1:98
    v_exp_f32 v172, v140
    v_exp_f32 v173, v141
    v_exp_f32 v174, v142
    v_exp_f32 v175, v143
    s_cmp_eq_u32 s13, 2
    s_cselect_b32 s10, s72, -1
    s_cselect_b32 s71, s74, 31
    v_pk_add_f32 v[160:161], v[160:161], 1.0 op_sel_hi:[1,0]
    v_pk_add_f32 v[162:163], v[162:163], 1.0 op_sel_hi:[1,0]
    v_pk_add_f32 v[164:165], v[164:165], 1.0 op_sel_hi:[1,0]
    v_pk_add_f32 v[166:167], v[166:167], 1.0 op_sel_hi:[1,0]
    v_pk_add_f32 v[168:169], v[168:169], 1.0 op_sel_hi:[1,0]
    v_pk_add_f32 v[170:171], v[170:171], 1.0 op_sel_hi:[1,0]
    v_pk_add_f32 v[172:173], v[172:173], 1.0 op_sel_hi:[1,0]
    v_readlane_b32 s62, v21, 0
    v_readlane_b32 s15, v21, s71
    v_pk_add_f32 v[174:175], v[174:175], 1.0 op_sel_hi:[1,0]
    v_rcp_f32 v160, v160
    s_waitcnt vmcnt(4) lgkmcnt(0)
    v_rcp_f32 v161, v161
    v_mfma_f32_32x32x16_bf16 v[80:95], v[176:179], v[24:27], 0
    ds_read2_b32 v[250:251], v9 offset0:32 offset1:48
    v_rcp_f32 v162, v162
    v_sub_f32 v236, v236, v0
    v_sub_f32 v237, v237, v1
    v_sub_f32 v238, v238, v2
    v_rcp_f32 v163, v163
    v_rcp_f32 v164, v164
    v_rcp_f32 v165, v165
    s_bfe_u32 s62, s62, 0x70003
    s_bfe_u32 s15, s15, 0x70003
    ds_read_b64_tr_b16 v[188:189], v3 offset:1024
    ds_read_b64_tr_b16 v[190:191], v3 offset:1536
    v_rcp_f32 v166, v166
    v_rcp_f32 v167, v167
    s_sub_u32 s82, s15, s17
    s_min_u32 s60, s62, 90
    ds_read_b64_tr_b16 v[240:241], v4 offset:0
    ds_read_b64_tr_b16 v[242:243], v4 offset:512
    v_rcp_f32 v168, v168
    v_rcp_f32 v169, v169
    v_mfma_f32_32x32x16_bf16 v[80:95], v[180:183], v[28:31], v[80:95]
    v_rcp_f32 v170, v170
    v_bitop3_b32 v12, v21, 56, v11 bitop3:0x6a
    v_cmp_gt_u32 s[4:5], s16, v21
    v_mul_f32 v239, v236, v236
    v_cvt_pk_bf16_f32 v220, v236, v237
    v_fmac_f32 v239, v237, v237
    v_rcp_f32 v171, v171
    v_rcp_f32 v172, v172
    s_cmp_ge_u32 s82, 8
    s_cselect_b32 s61, 1, 0
    v_cvt_pk_bf16_f32 v221, v238, 1.0
    v_fmac_f32 v239, v238, v238
    v_cvt_pk_bf16_f32 v218, v239, v20
    v_rcp_f32 v173, v173
    s_cmp_ge_u32 s13, 2
    s_cselect_b32 s61, s61, 0
    v_rcp_f32 v174, v174
    s_cmp_eq_u32 s61, 0
    s_cbranch_scc1 NOBP_F
    v_subrev_u32 v236, s60, v15
    v_and_b32 v236, 7, v236
    v_add_u32 v236, s60, v236
    v_lshl_add_u32 v236, v236, 8, v16
    ds_read_b64_tr_b16 v[192:193], v236 offset:0
    ds_read_b64_tr_b16 v[196:197], v236 offset:64
    ds_read_b64_tr_b16 v[200:201], v236 offset:128
    ds_read_b64_tr_b16 v[204:205], v236 offset:192
NOBP_F:
    v_rcp_f32 v175, v175
    v_pk_mul_f32 v[160:161], v[160:161], v[128:129]
    v_pk_mul_f32 v[162:163], v[162:163], v[130:131]
    v_pk_mul_f32 v[164:165], v[164:165], v[132:133]
    ds_read2_b32 v[248:249], v9 offset0:0 offset1:16
    ds_read_b64_tr_b16 v[184:185], v3 offset:0
    ds_read_b64_tr_b16 v[186:187], v3 offset:512
    v_pk_mul_f32 v[166:167], v[166:167], v[134:135]
    v_pk_mul_f32 v[168:169], v[168:169], v[136:137]
    v_pk_mul_f32 v[170:171], v[170:171], v[138:139]
    v_pk_mul_f32 v[172:173], v[172:173], v[140:141]
    v_pk_mul_f32 v[174:175], v[174:175], v[142:143]
    ds_read_b64_tr_b16 v[244:245], v4 offset:1024
    ds_read_b64_tr_b16 v[246:247], v4 offset:1536
    ds_read_b64 v[20:21], v8
    v_add_u32 v8, 0x100, v8
    v_add_u32 v9, 0x100, v9
    v_cvt_pk_bf16_f32 v176, v160, v161
    v_cvt_pk_bf16_f32 v177, v162, v163
    v_cvt_pk_bf16_f32 v178, v164, v165
    v_cvt_pk_bf16_f32 v179, v166, v167
    v_cvt_pk_bf16_f32 v180, v168, v169
    v_cvt_pk_bf16_f32 v181, v170, v171
    v_cvt_pk_bf16_f32 v182, v172, v173
    v_cvt_pk_bf16_f32 v183, v174, v175
    s_waitcnt lgkmcnt(0)
    v_exp_f32 v160, v144
    v_lshrrev_b32 v23, 12, v21
    s_cmp_ge_u32 s13, 3
    s_cselect_b32 s30, 6400000, 0
    s_cselect_b32 s46, 400000, 0
    v_mad_u32_u16 v248, v248, s66, v5 op_sel:[1,0,0,0]
    v_mad_u32_u16 v249, v249, s66, v5 op_sel:[1,0,0,0]
    v_mad_u32_u16 v250, v250, s66, v5 op_sel:[1,0,0,0]
    v_mad_u32_u16 v251, v251, s66, v5 op_sel:[1,0,0,0]
    v_exp_f32 v161, v145
    buffer_load_dwordx3 v[0:2], v23, s[44:47], 0 offen
    s_add_u32 m0, s87, 0
    s_nop 0
    buffer_load_dwordx4 v248, s[28:31], 0 offen offset:0 lds
    v_exp_f32 v162, v146
    v_mfma_f32_32x32x16_bf16 v[128:143], v[216:219], v[192:195], 0
    s_add_u32 m0, s87, 1024
    v_exp_f32 v163, v147
    v_exp_f32 v164, v148
    v_exp_f32 v165, v149
    v_smfmac_f32_32x32x32_bf16 v[128:143], v[208:211], v[184:191], v212
    buffer_load_dwordx4 v249, s[28:31], 0 offen offset:0 lds
    v_exp_f32 v166, v150
    v_exp_f32 v167, v151
    v_exp_f32 v168, v152
    v_exp_f32 v169, v153
    v_exp_f32 v170, v154
    v_exp_f32 v171, v155
    v_exp_f32 v172, v156
    v_exp_f32 v173, v157
    v_exp_f32 v174, v158
    v_exp_f32 v175, v159
    v_pk_add_f32 v[160:161], v[160:161], 1.0 op_sel_hi:[1,0]
    v_pk_add_f32 v[162:163], v[162:163], 1.0 op_sel_hi:[1,0]
    v_pk_add_f32 v[164:165], v[164:165], 1.0 op_sel_hi:[1,0]
    v_pk_add_f32 v[166:167], v[166:167], 1.0 op_sel_hi:[1,0]
    v_pk_add_f32 v[168:169], v[168:169], 1.0 op_sel_hi:[1,0]
    v_pk_add_f32 v[170:171], v[170:171], 1.0 op_sel_hi:[1,0]
    v_pk_add_f32 v[172:173], v[172:173], 1.0 op_sel_hi:[1,0]
    v_pk_add_f32 v[174:175], v[174:175], 1.0 op_sel_hi:[1,0]
    v_rcp_f32 v160, v160
    v_rcp_f32 v161, v161
    v_mfma_f32_32x32x16_bf16 v[96:111], v[176:179], v[24:27], 0
    v_rcp_f32 v162, v162
    v_rcp_f32 v163, v163
    v_rcp_f32 v164, v164
    v_rcp_f32 v165, v165
    v_rcp_f32 v166, v166
    v_rcp_f32 v167, v167
    v_rcp_f32 v168, v168
    v_rcp_f32 v169, v169
    v_mfma_f32_32x32x16_bf16 v[96:111], v[180:183], v[28:31], v[96:111]
    v_rcp_f32 v170, v170
    v_rcp_f32 v171, v171
    v_rcp_f32 v172, v172
    v_rcp_f32 v173, v173
    v_rcp_f32 v174, v174
    v_rcp_f32 v175, v175
    v_pk_mul_f32 v[160:161], v[160:161], v[144:145]
    v_pk_mul_f32 v[162:163], v[162:163], v[146:147]
    v_pk_mul_f32 v[164:165], v[164:165], v[148:149]
    v_pk_mul_f32 v[166:167], v[166:167], v[150:151]
    v_pk_mul_f32 v[168:169], v[168:169], v[152:153]
    v_pk_mul_f32 v[170:171], v[170:171], v[154:155]
    v_pk_mul_f32 v[172:173], v[172:173], v[156:157]
    v_pk_mul_f32 v[174:175], v[174:175], v[158:159]
    v_cvt_pk_bf16_f32 v176, v160, v161
    v_cvt_pk_bf16_f32 v177, v162, v163
    v_cvt_pk_bf16_f32 v178, v164, v165
    v_cvt_pk_bf16_f32 v179, v166, v167
    v_cvt_pk_bf16_f32 v180, v168, v169
    v_cvt_pk_bf16_f32 v181, v170, v171
    v_cvt_pk_bf16_f32 v182, v172, v173
    v_cvt_pk_bf16_f32 v183, v174, v175
    s_cmp_le_u32 s13, 2
    s_cbranch_scc1 TAIL_F
    s_waitcnt lgkmcnt(0)
    v_exp_f32 v160, v128
    v_exp_f32 v161, v129
    s_add_u32 m0, s87, 2048
    s_nop 0
    buffer_load_dwordx4 v250, s[28:31], 0 offen offset:0 lds
    v_exp_f32 v162, v130
    v_mfma_f32_32x32x16_bf16 v[144:159], v[216:219], v[196:199], 0
    s_add_u32 m0, s87, 3072
    v_exp_f32 v163, v131
    v_exp_f32 v164, v132
    v_exp_f32 v165, v133
    v_smfmac_f32_32x32x32_bf16 v[144:159], v[208:211], v[240:247], v212
    buffer_load_dwordx4 v251, s[28:31], 0 offen offset:0 lds
    v_exp_f32 v166, v134
    v_exp_f32 v167, v135
    v_exp_f32 v168, v136
    v_exp_f32 v169, v137
    v_exp_f32 v170, v138
    s_and_b64 exec, s[4:5], s[10:11]
    ds_write_b64 v12, v[220:221]
    s_mov_b64 exec, -1
    v_exp_f32 v171, v139
    v_exp_f32 v172, v140
    v_exp_f32 v173, v141
    v_exp_f32 v174, v142
    s_sub_u32 s13, s13, 1
    v_exp_f32 v175, v143
    v_pk_add_f32 v[160:161], v[160:161], 1.0 op_sel_hi:[1,0]
    v_pk_add_f32 v[162:163], v[162:163], 1.0 op_sel_hi:[1,0]
    v_pk_add_f32 v[164:165], v[164:165], 1.0 op_sel_hi:[1,0]
    v_pk_add_f32 v[166:167], v[166:167], 1.0 op_sel_hi:[1,0]
    v_pk_add_f32 v[168:169], v[168:169], 1.0 op_sel_hi:[1,0]
    v_pk_add_f32 v[170:171], v[170:171], 1.0 op_sel_hi:[1,0]
    v_pk_add_f32 v[172:173], v[172:173], 1.0 op_sel_hi:[1,0]
    v_pk_add_f32 v[174:175], v[174:175], 1.0 op_sel_hi:[1,0]
    v_rcp_f32 v160, v160
    v_rcp_f32 v161, v161
    v_mfma_f32_32x32x16_bf16 v[112:127], v[176:179], v[24:27], 0
    s_waitcnt vmcnt(5)
    v_rcp_f32 v162, v162
    v_rcp_f32 v163, v163
    v_rcp_f32 v164, v164
    v_rcp_f32 v165, v165
    v_rcp_f32 v166, v166
    v_rcp_f32 v167, v167
    s_mov_b32 s19, s69
    s_mov_b32 s69, s15
    ds_read_b64_tr_b16 v[188:189], v3 offset:5120
    ds_read_b64_tr_b16 v[190:191], v3 offset:5632
    v_rcp_f32 v168, v168
    v_rcp_f32 v169, v169
    v_mfma_f32_32x32x16_bf16 v[112:127], v[180:183], v[28:31], v[112:127]
    ds_read_b64_tr_b16 v[24:25], v13
    v_rcp_f32 v170, v170
    v_rcp_f32 v171, v171
    v_rcp_f32 v172, v172
    v_rcp_f32 v173, v173
    v_rcp_f32 v174, v174
    v_rcp_f32 v175, v175
    v_pk_mul_f32 v[160:161], v[160:161], v[128:129]
    ds_read_b64_tr_b16 v[184:185], v3 offset:4096
    ds_read_b64_tr_b16 v[186:187], v3 offset:4608
    ds_read_b64_tr_b16 v[26:27], v14 offset:512
    v_pk_mul_f32 v[162:163], v[162:163], v[130:131]
    v_pk_mul_f32 v[164:165], v[164:165], v[132:133]
    ds_read_b64_tr_b16 v[28:29], v13 offset:1024
    v_pk_mul_f32 v[166:167], v[166:167], v[134:135]
    v_pk_mul_f32 v[168:169], v[168:169], v[136:137]
    v_pk_mul_f32 v[170:171], v[170:171], v[138:139]
    v_pk_mul_f32 v[172:173], v[172:173], v[140:141]
    ds_read_b64_tr_b16 v[240:241], v4 offset:4096
    ds_read_b64_tr_b16 v[242:243], v4 offset:4608
    ds_read_b64_tr_b16 v[244:245], v4 offset:5120
    ds_read_b64_tr_b16 v[246:247], v4 offset:5632
    ds_read_b64_tr_b16 v[30:31], v14 offset:1536
    v_pk_mul_f32 v[174:175], v[174:175], v[142:143]
    v_cvt_pk_bf16_f32 v176, v160, v161
    v_cvt_pk_bf16_f32 v177, v162, v163
    v_cvt_pk_bf16_f32 v178, v164, v165
    s_and_b64 exec, s[4:5], s[10:11]
    ds_write_b64 v12, v[232:233]
    s_mov_b64 exec, -1
    v_cvt_pk_bf16_f32 v179, v166, v167
    v_cvt_pk_bf16_f32 v180, v168, v169
    v_cvt_pk_bf16_f32 v181, v170, v171
    v_cvt_pk_bf16_f32 v182, v172, v173
    v_cvt_pk_bf16_f32 v183, v174, v175
    s_cmp_lg_u32 s61, 0
    s_cbranch_scc1 FLUSH
BODY_C:
    s_cmp_gt_u32 s13, s68
    s_cbranch_scc1 KP_C
    s_setprio 0
KP_C:
    s_waitcnt lgkmcnt(0)
    v_exp_f32 v160, v144
    v_exp_f32 v161, v145
    s_add_u32 m0, s87, 3968
    s_nop 0
    buffer_load_dwordx4 v248, s[28:31], 0 offen offset:128 lds
    v_exp_f32 v162, v146
    v_mfma_f32_32x32x16_bf16 v[128:143], v[216:219], v[200:203], 0
    s_add_u32 m0, s87, 4992
    v_exp_f32 v163, v147
    v_exp_f32 v164, v148
    v_exp_f32 v165, v149
    v_smfmac_f32_32x32x32_bf16 v[128:143], v[208:211], v[184:191], v212
    buffer_load_dwordx4 v249, s[28:31], 0 offen offset:128 lds
    v_exp_f32 v166, v150
    v_exp_f32 v167, v151
    v_exp_f32 v168, v152
    v_exp_f32 v169, v153
    v_exp_f32 v170, v154
    v_exp_f32 v171, v155
    v_exp_f32 v172, v156
    v_exp_f32 v173, v157
    v_exp_f32 v174, v158
    v_exp_f32 v175, v159
    v_pk_add_f32 v[160:161], v[160:161], 1.0 op_sel_hi:[1,0]
    v_pk_add_f32 v[162:163], v[162:163], 1.0 op_sel_hi:[1,0]
    v_pk_add_f32 v[164:165], v[164:165], 1.0 op_sel_hi:[1,0]
    v_pk_add_f32 v[166:167], v[166:167], 1.0 op_sel_hi:[1,0]
    v_pk_add_f32 v[168:169], v[168:169], 1.0 op_sel_hi:[1,0]
    v_pk_add_f32 v[170:171], v[170:171], 1.0 op_sel_hi:[1,0]
    v_pk_add_f32 v[172:173], v[172:173], 1.0 op_sel_hi:[1,0]
    v_pk_add_f32 v[174:175], v[174:175], 1.0 op_sel_hi:[1,0]
    v_rcp_f32 v160, v160
    v_rcp_f32 v161, v161
    v_mfma_f32_32x32x16_bf16 v[64:79], v[176:179], v[24:27], v[64:79]
    v_rcp_f32 v162, v162
    v_rcp_f32 v163, v163
    v_rcp_f32 v164, v164
    v_rcp_f32 v165, v165
    v_rcp_f32 v166, v166
    v_rcp_f32 v167, v167
    v_rcp_f32 v168, v168
    v_rcp_f32 v169, v169
    v_mfma_f32_32x32x16_bf16 v[64:79], v[180:183], v[28:31], v[64:79]
    v_rcp_f32 v170, v170
    v_rcp_f32 v171, v171
    v_rcp_f32 v172, v172
    v_rcp_f32 v173, v173
    v_rcp_f32 v174, v174
    v_rcp_f32 v175, v175
    v_pk_mul_f32 v[160:161], v[160:161], v[144:145]
    v_pk_mul_f32 v[162:163], v[162:163], v[146:147]
    v_pk_mul_f32 v[164:165], v[164:165], v[148:149]
    v_pk_mul_f32 v[166:167], v[166:167], v[150:151]
    v_pk_mul_f32 v[168:169], v[168:169], v[152:153]
    v_pk_mul_f32 v[170:171], v[170:171], v[154:155]
    v_pk_mul_f32 v[172:173], v[172:173], v[156:157]
    v_pk_mul_f32 v[174:175], v[174:175], v[158:159]
    v_cvt_pk_bf16_f32 v176, v160, v161
    v_cvt_pk_bf16_f32 v177, v162, v163
    v_cvt_pk_bf16_f32 v178, v164, v165
    v_cvt_pk_bf16_f32 v179, v166, v167
    v_cvt_pk_bf16_f32 v180, v168, v169
    v_cvt_pk_bf16_f32 v181, v170, v171
    v_cvt_pk_bf16_f32 v182, v172, v173
    v_cvt_pk_bf16_f32 v183, v174, v175
    s_waitcnt lgkmcnt(0)
    v_exp_f32 v160, v128
    v_exp_f32 v161, v129
    s_add_u32 m0, s87, 6016
    s_nop 0
    buffer_load_dwordx4 v250, s[28:31], 0 offen offset:128 lds
    v_exp_f32 v162, v130
    v_mfma_f32_32x32x16_bf16 v[144:159], v[216:219], v[204:207], 0
    s_add_u32 m0, s87, 7040
    v_exp_f32 v163, v131
    v_exp_f32 v164, v132
    v_exp_f32 v165, v133
    v_smfmac_f32_32x32x32_bf16 v[144:159], v[208:211], v[240:247], v212
    buffer_load_dwordx4 v251, s[28:31], 0 offen offset:128 lds
    v_exp_f32 v166, v134
    v_exp_f32 v167, v135
    v_and_or_b32 v23, v21, 56, v10
    v_and_b32 v236, 0x3f8, v21
    v_exp_f32 v168, v136
    v_exp_f32 v169, v137
    v_exp_f32 v170, v138
    v_exp_f32 v171, v139
    ds_read_b64 v[216:217], v23 offset:2688
    ds_read2_b64 v[236:239], v236 offset0:0 offset1:98
    v_exp_f32 v172, v140
    v_exp_f32 v173, v141
    v_exp_f32 v174, v142
    v_exp_f32 v175, v143
    s_cmp_eq_u32 s13, 2
    s_cselect_b32 s10, s72, -1
    s_cselect_b32 s71, s74, 31
    v_pk_add_f32 v[160:161], v[160:161], 1.0 op_sel_hi:[1,0]
    v_pk_add_f32 v[162:163], v[162:163], 1.0 op_sel_hi:[1,0]
    v_pk_add_f32 v[164:165], v[164:165], 1.0 op_sel_hi:[1,0]
    v_pk_add_f32 v[166:167], v[166:167], 1.0 op_sel_hi:[1,0]
    v_pk_add_f32 v[168:169], v[168:169], 1.0 op_sel_hi:[1,0]
    v_pk_add_f32 v[170:171], v[170:171], 1.0 op_sel_hi:[1,0]
    v_pk_add_f32 v[172:173], v[172:173], 1.0 op_sel_hi:[1,0]
    v_readlane_b32 s62, v21, 0
    v_readlane_b32 s15, v21, s71
    v_pk_add_f32 v[174:175], v[174:175], 1.0 op_sel_hi:[1,0]
    v_rcp_f32 v160, v160
    s_waitcnt vmcnt(4) lgkmcnt(0)
    v_rcp_f32 v161, v161
    v_mfma_f32_32x32x16_bf16 v[80:95], v[176:179], v[24:27], v[80:95]
    ds_read2_b32 v[250:251], v9 offset0:32 offset1:48
    v_rcp_f32 v162, v162
    v_sub_f32 v236, v236, v0
    v_sub_f32 v237, v237, v1
    v_sub_f32 v238, v238, v2
    v_rcp_f32 v163, v163
    v_rcp_f32 v164, v164
    v_rcp_f32 v165, v165
    s_bfe_u32 s62, s62, 0x70003
    s_bfe_u32 s15, s15, 0x70003
    ds_read_b64_tr_b16 v[188:189], v3 offset:1024
    ds_read_b64_tr_b16 v[190:191], v3 offset:1536
    v_rcp_f32 v166, v166
    v_rcp_f32 v167, v167
    s_sub_u32 s82, s15, s17
    s_min_u32 s60, s62, 90
    ds_read_b64_tr_b16 v[240:241], v4 offset:0
    ds_read_b64_tr_b16 v[242:243], v4 offset:512
    v_rcp_f32 v168, v168
    v_rcp_f32 v169, v169
    v_mfma_f32_32x32x16_bf16 v[80:95], v[180:183], v[28:31], v[80:95]
    v_rcp_f32 v170, v170
    v_bitop3_b32 v12, v21, 56, v11 bitop3:0x6a
    v_cmp_gt_u32 s[4:5], s16, v21
    v_mul_f32 v239, v236, v236
    v_cvt_pk_bf16_f32 v220, v236, v237
    v_fmac_f32 v239, v237, v237
    v_rcp_f32 v171, v171
    v_rcp_f32 v172, v172
    s_cmp_ge_u32 s82, 8
    s_cselect_b32 s61, 1, 0
    v_cvt_pk_bf16_f32 v221, v238, 1.0
    v_fmac_f32 v239, v238, v238
    v_cvt_pk_bf16_f32 v218, v239, v20
    v_rcp_f32 v173, v173
    s_cmp_ge_u32 s13, 2
    s_cselect_b32 s61, s61, 0
    v_rcp_f32 v174, v174
    s_cmp_eq_u32 s61, 0
    s_cbranch_scc1 NOBP_C
    v_subrev_u32 v236, s60, v15
    v_and_b32 v236, 7, v236
    v_add_u32 v236, s60, v236
    v_lshl_add_u32 v236, v236, 8, v16
    ds_read_b64_tr_b16 v[192:193], v236 offset:0
    ds_read_b64_tr_b16 v[196:197], v236 offset:64
    ds_read_b64_tr_b16 v[200:201], v236 offset:128
    ds_read_b64_tr_b16 v[204:205], v236 offset:192
NOBP_C:
    v_rcp_f32 v175, v175
    v_pk_mul_f32 v[160:161], v[160:161], v[128:129]
    v_pk_mul_f32 v[162:163], v[162:163], v[130:131]
    v_pk_mul_f32 v[164:165], v[164:165], v[132:133]
    ds_read2_b32 v[248:249], v9 offset0:0 offset1:16
    ds_read_b64_tr_b16 v[184:185], v3 offset:0
    ds_read_b64_tr_b16 v[186:187], v3 offset:512
    v_pk_mul_f32 v[166:167], v[166:167], v[134:135]
    v_pk_mul_f32 v[168:169], v[168:169], v[136:137]
    v_pk_mul_f32 v[170:171], v[170:171], v[138:139]
    v_pk_mul_f32 v[172:173], v[172:173], v[140:141]
    v_pk_mul_f32 v[174:175], v[174:175], v[142:143]
    ds_read_b64_tr_b16 v[244:245], v4 offset:1024
    ds_read_b64_tr_b16 v[246:247], v4 offset:1536
    ds_read_b64 v[20:21], v8
    v_add_u32 v8, 0x100, v8
    v_add_u32 v9, 0x100, v9
    v_cvt_pk_bf16_f32 v176, v160, v161
    v_cvt_pk_bf16_f32 v177, v162, v163
    v_cvt_pk_bf16_f32 v178, v164, v165
    v_cvt_pk_bf16_f32 v179, v166, v167
    v_cvt_pk_bf16_f32 v180, v168, v169
    v_cvt_pk_bf16_f32 v181, v170, v171
    v_cvt_pk_bf16_f32 v182, v172, v173
    v_cvt_pk_bf16_f32 v183, v174, v175
    s_waitcnt lgkmcnt(0)
    v_exp_f32 v160, v144
    v_lshrrev_b32 v23, 12, v21
    s_cmp_ge_u32 s13, 3
    s_cselect_b32 s30, 6400000, 0
    s_cselect_b32 s46, 400000, 0
    v_mad_u32_u16 v248, v248, s66, v5 op_sel:[1,0,0,0]
    v_mad_u32_u16 v249, v249, s66, v5 op_sel:[1,0,0,0]
    v_mad_u32_u16 v250, v250, s66, v5 op_sel:[1,0,0,0]
    v_mad_u32_u16 v251, v251, s66, v5 op_sel:[1,0,0,0]
    v_exp_f32 v161, v145
    buffer_load_dwordx3 v[0:2], v23, s[44:47], 0 offen
    s_add_u32 m0, s87, 0
    s_nop 0
    buffer_load_dwordx4 v248, s[28:31], 0 offen offset:0 lds
    v_exp_f32 v162, v146
    v_mfma_f32_32x32x16_bf16 v[128:143], v[216:219], v[192:195], 0
    s_add_u32 m0, s87, 1024
    v_exp_f32 v163, v147
    v_exp_f32 v164, v148
    v_exp_f32 v165, v149
    v_smfmac_f32_32x32x32_bf16 v[128:143], v[208:211], v[184:191], v212
    buffer_load_dwordx4 v249, s[28:31], 0 offen offset:0 lds
    v_exp_f32 v166, v150
    v_exp_f32 v167, v151
    v_exp_f32 v168, v152
    v_exp_f32 v169, v153
    v_exp_f32 v170, v154
    v_exp_f32 v171, v155
    v_exp_f32 v172, v156
    v_exp_f32 v173, v157
    v_exp_f32 v174, v158
    v_exp_f32 v175, v159
    v_pk_add_f32 v[160:161], v[160:161], 1.0 op_sel_hi:[1,0]
    v_pk_add_f32 v[162:163], v[162:163], 1.0 op_sel_hi:[1,0]
    v_pk_add_f32 v[164:165], v[164:165], 1.0 op_sel_hi:[1,0]
    v_pk_add_f32 v[166:167], v[166:167], 1.0 op_sel_hi:[1,0]
    v_pk_add_f32 v[168:169], v[168:169], 1.0 op_sel_hi:[1,0]
    v_pk_add_f32 v[170:171], v[170:171], 1.0 op_sel_hi:[1,0]
    v_pk_add_f32 v[172:173], v[172:173], 1.0 op_sel_hi:[1,0]
    v_pk_add_f32 v[174:175], v[174:175], 1.0 op_sel_hi:[1,0]
    v_rcp_f32 v160, v160
    v_rcp_f32 v161, v161
    v_mfma_f32_32x32x16_bf16 v[96:111], v[176:179], v[24:27], v[96:111]
    v_rcp_f32 v162, v162
    v_rcp_f32 v163, v163
    v_rcp_f32 v164, v164
    v_rcp_f32 v165, v165
    v_rcp_f32 v166, v166
    v_rcp_f32 v167, v167
    v_rcp_f32 v168, v168
    v_rcp_f32 v169, v169
    v_mfma_f32_32x32x16_bf16 v[96:111], v[180:183], v[28:31], v[96:111]
    v_rcp_f32 v170, v170
    v_rcp_f32 v171, v171
    v_rcp_f32 v172, v172
    v_rcp_f32 v173, v173
    v_rcp_f32 v174, v174
    v_rcp_f32 v175, v175
    v_pk_mul_f32 v[160:161], v[160:161], v[144:145]
    v_pk_mul_f32 v[162:163], v[162:163], v[146:147]
    v_pk_mul_f32 v[164:165], v[164:165], v[148:149]
    v_pk_mul_f32 v[166:167], v[166:167], v[150:151]
    v_pk_mul_f32 v[168:169], v[168:169], v[152:153]
    v_pk_mul_f32 v[170:171], v[170:171], v[154:155]
    v_pk_mul_f32 v[172:173], v[172:173], v[156:157]
    v_pk_mul_f32 v[174:175], v[174:175], v[158:159]
    v_cvt_pk_bf16_f32 v176, v160, v161
    v_cvt_pk_bf16_f32 v177, v162, v163
    v_cvt_pk_bf16_f32 v178, v164, v165
    v_cvt_pk_bf16_f32 v179, v166, v167
    v_cvt_pk_bf16_f32 v180, v168, v169
    v_cvt_pk_bf16_f32 v181, v170, v171
    v_cvt_pk_bf16_f32 v182, v172, v173
    v_cvt_pk_bf16_f32 v183, v174, v175
    s_cmp_le_u32 s13, 2
    s_cbranch_scc1 TAIL_C
    s_waitcnt lgkmcnt(0)
    v_exp_f32 v160, v128
    v_exp_f32 v161, v129
    s_add_u32 m0, s87, 2048
    s_nop 0
    buffer_load_dwordx4 v250, s[28:31], 0 offen offset:0 lds
    v_exp_f32 v162, v130
    v_mfma_f32_32x32x16_bf16 v[144:159], v[216:219], v[196:199], 0
    s_add_u32 m0, s87, 3072
    v_exp_f32 v163, v131
    v_exp_f32 v164, v132
    v_exp_f32 v165, v133
    v_smfmac_f32_32x32x32_bf16 v[144:159], v[208:211], v[240:247], v212
    buffer_load_dwordx4 v251, s[28:31], 0 offen offset:0 lds
    v_exp_f32 v166, v134
    v_exp_f32 v167, v135
    v_exp_f32 v168, v136
    v_exp_f32 v169, v137
    v_exp_f32 v170, v138
    s_and_b64 exec, s[4:5], s[10:11]
    ds_write_b64 v12, v[220:221]
    s_mov_b64 exec, -1
    v_exp_f32 v171, v139
    v_exp_f32 v172, v140
    v_exp_f32 v173, v141
    v_exp_f32 v174, v142
    s_sub_u32 s13, s13, 1
    v_exp_f32 v175, v143
    v_pk_add_f32 v[160:161], v[160:161], 1.0 op_sel_hi:[1,0]
    v_pk_add_f32 v[162:163], v[162:163], 1.0 op_sel_hi:[1,0]
    v_pk_add_f32 v[164:165], v[164:165], 1.0 op_sel_hi:[1,0]
    v_pk_add_f32 v[166:167], v[166:167], 1.0 op_sel_hi:[1,0]
    v_pk_add_f32 v[168:169], v[168:169], 1.0 op_sel_hi:[1,0]
    v_pk_add_f32 v[170:171], v[170:171], 1.0 op_sel_hi:[1,0]
    v_pk_add_f32 v[172:173], v[172:173], 1.0 op_sel_hi:[1,0]
    v_pk_add_f32 v[174:175], v[174:175], 1.0 op_sel_hi:[1,0]
    v_rcp_f32 v160, v160
    v_rcp_f32 v161, v161
    v_mfma_f32_32x32x16_bf16 v[112:127], v[176:179], v[24:27], v[112:127]
    s_waitcnt vmcnt(5)
    v_rcp_f32 v162, v162
    v_rcp_f32 v163, v163
    v_rcp_f32 v164, v164
    v_rcp_f32 v165, v165
    v_rcp_f32 v166, v166
    v_rcp_f32 v167, v167
    s_mov_b32 s19, s69
    s_mov_b32 s69, s15
    ds_read_b64_tr_b16 v[188:189], v3 offset:5120
    ds_read_b64_tr_b16 v[190:191], v3 offset:5632
    v_rcp_f32 v168, v168
    v_rcp_f32 v169, v169
    v_mfma_f32_32x32x16_bf16 v[112:127], v[180:183], v[28:31], v[112:127]
    ds_read_b64_tr_b16 v[24:25], v13
    v_rcp_f32 v170, v170
    v_rcp_f32 v171, v171
    v_rcp_f32 v172, v172
    v_rcp_f32 v173, v173
    v_rcp_f32 v174, v174
    v_rcp_f32 v175, v175
    v_pk_mul_f32 v[160:161], v[160:161], v[128:129]
    ds_read_b64_tr_b16 v[184:185], v3 offset:4096
    ds_read_b64_tr_b16 v[186:187], v3 offset:4608
    ds_read_b64_tr_b16 v[26:27], v14 offset:512
    v_pk_mul_f32 v[162:163], v[162:163], v[130:131]
    v_pk_mul_f32 v[164:165], v[164:165], v[132:133]
    ds_read_b64_tr_b16 v[28:29], v13 offset:1024
    v_pk_mul_f32 v[166:167], v[166:167], v[134:135]
    v_pk_mul_f32 v[168:169], v[168:169], v[136:137]
    v_pk_mul_f32 v[170:171], v[170:171], v[138:139]
    v_pk_mul_f32 v[172:173], v[172:173], v[140:141]
    ds_read_b64_tr_b16 v[240:241], v4 offset:4096
    ds_read_b64_tr_b16 v[242:243], v4 offset:4608
    ds_read_b64_tr_b16 v[244:245], v4 offset:5120
    ds_read_b64_tr_b16 v[246:247], v4 offset:5632
    ds_read_b64_tr_b16 v[30:31], v14 offset:1536
    v_pk_mul_f32 v[174:175], v[174:175], v[142:143]
    v_cvt_pk_bf16_f32 v176, v160, v161
    v_cvt_pk_bf16_f32 v177, v162, v163
    v_cvt_pk_bf16_f32 v178, v164, v165
    s_and_b64 exec, s[4:5], s[10:11]
    ds_write_b64 v12, v[232:233]
    s_mov_b64 exec, -1
    v_cvt_pk_bf16_f32 v179, v166, v167
    v_cvt_pk_bf16_f32 v180, v168, v169
    v_cvt_pk_bf16_f32 v181, v170, v171
    v_cvt_pk_bf16_f32 v182, v172, v173
    v_cvt_pk_bf16_f32 v183, v174, v175
    s_cmp_lg_u32 s61, 0
    s_cbranch_scc1 FLUSH
    s_branch BODY_C
TAIL_F:
    v_mfma_f32_32x32x16_bf16 v[112:127], v[176:179], v[24:27], 0
    v_mfma_f32_32x32x16_bf16 v[112:127], v[180:183], v[28:31], v[112:127]
    s_branch TAIL
TAIL_C:
    v_mfma_f32_32x32x16_bf16 v[112:127], v[176:179], v[24:27], v[112:127]
    v_mfma_f32_32x32x16_bf16 v[112:127], v[180:183], v[28:31], v[112:127]
TAIL:
    s_cmp_eq_u32 s13, 1
    s_cbranch_scc1 TAIL1
    s_mov_b32 s19, s69
    s_mov_b32 s69, s15
    s_mov_b32 s13, 1
    s_mov_b32 s73, 1
    s_cmp_eq_u32 s70, 0
    s_cbranch_scc1 PART1
    s_cmp_eq_u32 s70, 1
    s_cbranch_scc1 PART2
    s_cmp_eq_u32 s70, 2
    s_cbranch_scc1 PART3
PART4:
    s_waitcnt lgkmcnt(0)
    v_exp_f32 v160, v128
    v_exp_f32 v161, v129
    v_exp_f32 v162, v130
    v_mfma_f32_32x32x16_bf16 v[144:159], v[216:219], v[196:199], 0
    v_exp_f32 v163, v131
    v_exp_f32 v164, v132
    v_exp_f32 v165, v133
    v_smfmac_f32_32x32x32_bf16 v[144:159], v[208:211], v[240:247], v212
    v_exp_f32 v166, v134
    v_exp_f32 v167, v135
    v_exp_f32 v168, v136
    v_exp_f32 v169, v137
    v_exp_f32 v170, v138
    v_exp_f32 v171, v139
    v_exp_f32 v172, v140
    v_exp_f32 v173, v141
    v_exp_f32 v174, v142
    v_exp_f32 v175, v143
    v_pk_add_f32 v[160:161], v[160:161], 1.0 op_sel_hi:[1,0]
    v_pk_add_f32 v[162:163], v[162:163], 1.0 op_sel_hi:[1,0]
    v_pk_add_f32 v[164:165], v[164:165], 1.0 op_sel_hi:[1,0]
    v_pk_add_f32 v[166:167], v[166:167], 1.0 op_sel_hi:[1,0]
    v_pk_add_f32 v[168:169], v[168:169], 1.0 op_sel_hi:[1,0]
    v_pk_add_f32 v[170:171], v[170:171], 1.0 op_sel_hi:[1,0]
    v_pk_add_f32 v[172:173], v[172:173], 1.0 op_sel_hi:[1,0]
    v_pk_add_f32 v[174:175], v[174:175], 1.0 op_sel_hi:[1,0]
    s_waitcnt vmcnt(0)
    ds_read_b64_tr_b16 v[184:185], v3 offset:4096
    ds_read_b64_tr_b16 v[186:187], v3 offset:4608
    ds_read_b64_tr_b16 v[188:189], v3 offset:5120
    ds_read_b64_tr_b16 v[190:191], v3 offset:5632
    ds_read_b64_tr_b16 v[240:241], v4 offset:4096
    ds_read_b64_tr_b16 v[242:243], v4 offset:4608
    ds_read_b64_tr_b16 v[244:245], v4 offset:5120
    ds_read_b64_tr_b16 v[246:247], v4 offset:5632
    v_rcp_f32 v160, v160
    v_rcp_f32 v161, v161
    v_rcp_f32 v162, v162
    v_rcp_f32 v163, v163
    v_rcp_f32 v164, v164
    v_rcp_f32 v165, v165
    v_rcp_f32 v166, v166
    v_rcp_f32 v167, v167
    s_and_b64 exec, s[4:5], s[10:11]
    ds_write_b64 v12, v[220:221]
    s_mov_b64 exec, -1
    ds_read_b64_tr_b16 v[24:25], v13
    ds_read_b64_tr_b16 v[26:27], v14 offset:512
    ds_read_b64_tr_b16 v[28:29], v13 offset:1024
    ds_read_b64_tr_b16 v[30:31], v14 offset:1536
    s_and_b64 exec, s[4:5], s[10:11]
    ds_write_b64 v12, v[232:233]
    s_mov_b64 exec, -1
    v_rcp_f32 v168, v168
    v_rcp_f32 v169, v169
    v_rcp_f32 v170, v170
    v_rcp_f32 v171, v171
    v_rcp_f32 v172, v172
    v_rcp_f32 v173, v173
    v_rcp_f32 v174, v174
    v_rcp_f32 v175, v175
    v_pk_mul_f32 v[160:161], v[160:161], v[128:129]
    v_pk_mul_f32 v[162:163], v[162:163], v[130:131]
    v_pk_mul_f32 v[164:165], v[164:165], v[132:133]
    v_pk_mul_f32 v[166:167], v[166:167], v[134:135]
    v_pk_mul_f32 v[168:169], v[168:169], v[136:137]
    v_pk_mul_f32 v[170:171], v[170:171], v[138:139]
    v_pk_mul_f32 v[172:173], v[172:173], v[140:141]
    v_pk_mul_f32 v[174:175], v[174:175], v[142:143]
    v_cvt_pk_bf16_f32 v176, v160, v161
    v_cvt_pk_bf16_f32 v177, v162, v163
    v_cvt_pk_bf16_f32 v178, v164, v165
    v_cvt_pk_bf16_f32 v179, v166, v167
    v_cvt_pk_bf16_f32 v180, v168, v169
    v_cvt_pk_bf16_f32 v181, v170, v171
    v_cvt_pk_bf16_f32 v182, v172, v173
    v_cvt_pk_bf16_f32 v183, v174, v175
    s_cmp_lg_u32 s61, 0
    s_cbranch_scc1 FLUSH
PART4B:
    s_waitcnt lgkmcnt(0)
    v_exp_f32 v160, v144
    v_exp_f32 v161, v145
    v_exp_f32 v162, v146
    v_mfma_f32_32x32x16_bf16 v[128:143], v[216:219], v[200:203], 0
    v_exp_f32 v163, v147
    v_exp_f32 v164, v148
    v_exp_f32 v165, v149
    v_smfmac_f32_32x32x32_bf16 v[128:143], v[208:211], v[184:191], v212
    v_exp_f32 v166, v150
    v_exp_f32 v167, v151
    v_exp_f32 v168, v152
    v_exp_f32 v169, v153
    v_exp_f32 v170, v154
    v_exp_f32 v171, v155
    v_exp_f32 v172, v156
    v_exp_f32 v173, v157
    v_exp_f32 v174, v158
    v_exp_f32 v175, v159
    v_lshrrev_b32 v236, 7, v235
    v_and_b32 v237, 0x70, v235
    v_lshl_or_b32 v234, v236, 8, v237
    s_add_u32 m0, s22, 0
    s_add_u32 s83, s86, 0
    buffer_load_dwordx4 v234, s[40:43], s83 offen lds
    s_add_u32 m0, s22, 1024
    s_add_u32 s83, s86, 2048
    buffer_load_dwordx4 v234, s[40:43], s83 offen lds
    s_add_u32 m0, s23, 0
    s_add_u32 s83, s86, 4096
    buffer_load_dwordx4 v234, s[40:43], s83 offen lds
    s_add_u32 m0, s23, 1024
    s_add_u32 s83, s86, 6144
    buffer_load_dwordx4 v234, s[40:43], s83 offen lds
    s_cmp_lt_u32 s3, 4
    s_cbranch_scc1 EL1
    s_add_u32 s82, s87, 4096
    s_add_u32 m0, s87, 0
    s_add_u32 s83, s82, 0
    buffer_load_dwordx4 v235, s[36:39], s83 offen lds
    s_add_u32 m0, s87, 1024
    s_add_u32 s83, s82, 1024
    buffer_load_dwordx4 v235, s[36:39], s83 offen lds
    s_add_u32 m0, s87, 2048
    s_add_u32 s83, s82, 2048
    buffer_load_dwordx4 v235, s[36:39], s83 offen lds
    s_add_u32 m0, s87, 3072
    s_add_u32 s83, s82, 3072
    buffer_load_dwordx4 v235, s[36:39], s83 offen lds
    s_add_u32 m0, s87, 4096
    s_add_u32 s83, s82, 4096
    buffer_load_dwordx4 v235, s[36:39], s83 offen lds
    s_add_u32 m0, s87, 5120
    s_add_u32 s83, s82, 5120
    buffer_load_dwordx4 v235, s[36:39], s83 offen lds
    s_add_u32 m0, s87, 6144
    s_add_u32 s83, s82, 6144
    buffer_load_dwordx4 v235, s[36:39], s83 offen lds
    s_add_u32 m0, s87, 7168
    s_add_u32 s83, s82, 7168
    buffer_load_dwordx4 v235, s[36:39], s83 offen lds
EL1:
    v_pk_add_f32 v[160:161], v[160:161], 1.0 op_sel_hi:[1,0]
    v_pk_add_f32 v[162:163], v[162:163], 1.0 op_sel_hi:[1,0]
    v_pk_add_f32 v[164:165], v[164:165], 1.0 op_sel_hi:[1,0]
    v_pk_add_f32 v[166:167], v[166:167], 1.0 op_sel_hi:[1,0]
    v_pk_add_f32 v[168:169], v[168:169], 1.0 op_sel_hi:[1,0]
    v_pk_add_f32 v[170:171], v[170:171], 1.0 op_sel_hi:[1,0]
    v_pk_add_f32 v[172:173], v[172:173], 1.0 op_sel_hi:[1,0]
    v_pk_add_f32 v[174:175], v[174:175], 1.0 op_sel_hi:[1,0]
    v_rcp_f32 v160, v160
    v_rcp_f32 v161, v161
    s_cmp_lg_u32 s61, 0
    s_cbranch_scc1 SF_4_1
    v_mfma_f32_32x32x16_bf16 v[64:79], v[176:179], v[24:27], v[64:79]
    s_branch SG_4_1
SF_4_1:
    v_mfma_f32_32x32x16_bf16 v[64:79], v[176:179], v[24:27], 0
SG_4_1:
    v_rcp_f32 v162, v162
    v_rcp_f32 v163, v163
    v_rcp_f32 v164, v164
    v_rcp_f32 v165, v165
    v_rcp_f32 v166, v166
    v_rcp_f32 v167, v167
    v_rcp_f32 v168, v168
    v_rcp_f32 v169, v169
    v_mfma_f32_32x32x16_bf16 v[64:79], v[180:183], v[28:31], v[64:79]
    v_rcp_f32 v170, v170
    v_rcp_f32 v171, v171
    v_rcp_f32 v172, v172
    v_rcp_f32 v173, v173
    v_rcp_f32 v174, v174
    v_rcp_f32 v175, v175
    v_pk_mul_f32 v[160:161], v[160:161], v[144:145]
    v_pk_mul_f32 v[162:163], v[162:163], v[146:147]
    v_pk_mul_f32 v[164:165], v[164:165], v[148:149]
    v_pk_mul_f32 v[166:167], v[166:167], v[150:151]
    v_pk_mul_f32 v[168:169], v[168:169], v[152:153]
    v_pk_mul_f32 v[170:171], v[170:171], v[154:155]
    v_pk_mul_f32 v[172:173], v[172:173], v[156:157]
    v_pk_mul_f32 v[174:175], v[174:175], v[158:159]
    v_cvt_pk_bf16_f32 v176, v160, v161
    v_cvt_pk_bf16_f32 v177, v162, v163
    v_cvt_pk_bf16_f32 v178, v164, v165
    v_cvt_pk_bf16_f32 v179, v166, v167
    v_cvt_pk_bf16_f32 v180, v168, v169
    v_cvt_pk_bf16_f32 v181, v170, v171
    v_cvt_pk_bf16_f32 v182, v172, v173
    v_cvt_pk_bf16_f32 v183, v174, v175
    s_waitcnt lgkmcnt(0)
    v_exp_f32 v160, v128
    v_exp_f32 v161, v129
    v_exp_f32 v162, v130
    v_mfma_f32_32x32x16_bf16 v[144:159], v[216:219], v[204:207], 0
    v_exp_f32 v163, v131
    v_exp_f32 v164, v132
    v_exp_f32 v165, v133
    v_smfmac_f32_32x32x32_bf16 v[144:159], v[208:211], v[240:247], v212
    v_exp_f32 v166, v134
    v_exp_f32 v167, v135
    v_exp_f32 v168, v136
    v_exp_f32 v169, v137
    v_exp_f32 v170, v138
    v_exp_f32 v171, v139
    v_exp_f32 v172, v140
    v_exp_f32 v173, v141
    v_exp_f32 v174, v142
    v_exp_f32 v175, v143
    v_pk_add_f32 v[160:161], v[160:161], 1.0 op_sel_hi:[1,0]
    v_pk_add_f32 v[162:163], v[162:163], 1.0 op_sel_hi:[1,0]
    v_pk_add_f32 v[164:165], v[164:165], 1.0 op_sel_hi:[1,0]
    v_pk_add_f32 v[166:167], v[166:167], 1.0 op_sel_hi:[1,0]
    v_pk_add_f32 v[168:169], v[168:169], 1.0 op_sel_hi:[1,0]
    v_pk_add_f32 v[170:171], v[170:171], 1.0 op_sel_hi:[1,0]
    v_pk_add_f32 v[172:173], v[172:173], 1.0 op_sel_hi:[1,0]
    v_pk_add_f32 v[174:175], v[174:175], 1.0 op_sel_hi:[1,0]
    v_rcp_f32 v160, v160
    v_rcp_f32 v161, v161
    s_cmp_lg_u32 s61, 0
    s_cbranch_scc1 SF_4_2
    v_mfma_f32_32x32x16_bf16 v[80:95], v[176:179], v[24:27], v[80:95]
    s_branch SG_4_2
SF_4_2:
    v_mfma_f32_32x32x16_bf16 v[80:95], v[176:179], v[24:27], 0
SG_4_2:
    v_rcp_f32 v162, v162
    v_rcp_f32 v163, v163
    v_rcp_f32 v164, v164
    v_rcp_f32 v165, v165
    v_rcp_f32 v166, v166
    v_rcp_f32 v167, v167
    v_rcp_f32 v168, v168
    v_rcp_f32 v169, v169
    v_mfma_f32_32x32x16_bf16 v[80:95], v[180:183], v[28:31], v[80:95]
    v_rcp_f32 v170, v170
    v_rcp_f32 v171, v171
    v_rcp_f32 v172, v172
    v_rcp_f32 v173, v173
    v_rcp_f32 v174, v174
    v_rcp_f32 v175, v175
    v_pk_mul_f32 v[160:161], v[160:161], v[128:129]
    v_pk_mul_f32 v[162:163], v[162:163], v[130:131]
    v_pk_mul_f32 v[164:165], v[164:165], v[132:133]
    v_pk_mul_f32 v[166:167], v[166:167], v[134:135]
    v_pk_mul_f32 v[168:169], v[168:169], v[136:137]
    v_pk_mul_f32 v[170:171], v[170:171], v[138:139]
    v_pk_mul_f32 v[172:173], v[172:173], v[140:141]
    v_pk_mul_f32 v[174:175], v[174:175], v[142:143]
    v_cvt_pk_bf16_f32 v176, v160, v161
    v_cvt_pk_bf16_f32 v177, v162, v163
    v_cvt_pk_bf16_f32 v178, v164, v165
    v_cvt_pk_bf16_f32 v179, v166, v167
    v_cvt_pk_bf16_f32 v180, v168, v169
    v_cvt_pk_bf16_f32 v181, v170, v171
    v_cvt_pk_bf16_f32 v182, v172, v173
    v_cvt_pk_bf16_f32 v183, v174, v175
    s_waitcnt lgkmcnt(0)
    v_exp_f32 v160, v144
    v_exp_f32 v161, v145
    v_exp_f32 v162, v146
    v_exp_f32 v163, v147
    v_exp_f32 v164, v148
    v_exp_f32 v165, v149
    v_exp_f32 v166, v150
    v_exp_f32 v167, v151
    v_exp_f32 v168, v152
    v_exp_f32 v169, v153
    v_exp_f32 v170, v154
    v_exp_f32 v171, v155
    v_exp_f32 v172, v156
    v_exp_f32 v173, v157
    v_exp_f32 v174, v158
    v_exp_f32 v175, v159
    v_pk_add_f32 v[160:161], v[160:161], 1.0 op_sel_hi:[1,0]
    v_pk_add_f32 v[162:163], v[162:163], 1.0 op_sel_hi:[1,0]
    v_pk_add_f32 v[164:165], v[164:165], 1.0 op_sel_hi:[1,0]
    v_pk_add_f32 v[166:167], v[166:167], 1.0 op_sel_hi:[1,0]
    v_pk_add_f32 v[168:169], v[168:169], 1.0 op_sel_hi:[1,0]
    v_pk_add_f32 v[170:171], v[170:171], 1.0 op_sel_hi:[1,0]
    v_pk_add_f32 v[172:173], v[172:173], 1.0 op_sel_hi:[1,0]
    v_pk_add_f32 v[174:175], v[174:175], 1.0 op_sel_hi:[1,0]
    v_rcp_f32 v160, v160
    v_rcp_f32 v161, v161
    s_cmp_lg_u32 s61, 0
    s_cbranch_scc1 SF_4_3
    v_mfma_f32_32x32x16_bf16 v[96:111], v[176:179], v[24:27], v[96:111]
    s_branch SG_4_3
SF_4_3:
    v_mfma_f32_32x32x16_bf16 v[96:111], v[176:179], v[24:27], 0
SG_4_3:
    v_rcp_f32 v162, v162
    v_rcp_f32 v163, v163
    v_rcp_f32 v164, v164
    v_rcp_f32 v165, v165
    v_rcp_f32 v166, v166
    v_rcp_f32 v167, v167
    v_rcp_f32 v168, v168
    v_rcp_f32 v169, v169
    v_mfma_f32_32x32x16_bf16 v[96:111], v[180:183], v[28:31], v[96:111]
    v_rcp_f32 v170, v170
    v_rcp_f32 v171, v171
    v_rcp_f32 v172, v172
    v_rcp_f32 v173, v173
    v_rcp_f32 v174, v174
    v_rcp_f32 v175, v175
    v_pk_mul_f32 v[160:161], v[160:161], v[144:145]
    v_pk_mul_f32 v[162:163], v[162:163], v[146:147]
    v_pk_mul_f32 v[164:165], v[164:165], v[148:149]
    v_pk_mul_f32 v[166:167], v[166:167], v[150:151]
    v_pk_mul_f32 v[168:169], v[168:169], v[152:153]
    v_pk_mul_f32 v[170:171], v[170:171], v[154:155]
    v_pk_mul_f32 v[172:173], v[172:173], v[156:157]
    v_pk_mul_f32 v[174:175], v[174:175], v[158:159]
    v_cvt_pk_bf16_f32 v176, v160, v161
    v_cvt_pk_bf16_f32 v177, v162, v163
    v_cvt_pk_bf16_f32 v178, v164, v165
    v_cvt_pk_bf16_f32 v179, v166, v167
    v_cvt_pk_bf16_f32 v180, v168, v169
    v_cvt_pk_bf16_f32 v181, v170, v171
    v_cvt_pk_bf16_f32 v182, v172, v173
    v_cvt_pk_bf16_f32 v183, v174, v175
    s_cmp_lg_u32 s61, 0
    s_cbranch_scc1 SF_4_4
    v_mfma_f32_32x32x16_bf16 v[112:127], v[176:179], v[24:27], v[112:127]
    s_branch SG_4_4
SF_4_4:
    v_mfma_f32_32x32x16_bf16 v[112:127], v[176:179], v[24:27], 0
SG_4_4:
    v_mfma_f32_32x32x16_bf16 v[112:127], v[180:183], v[28:31], v[112:127]
    s_branch TAIL2
PART3:
    s_waitcnt lgkmcnt(0)
    v_exp_f32 v160, v128
    v_exp_f32 v161, v129
    v_exp_f32 v162, v130
    v_mfma_f32_32x32x16_bf16 v[144:159], v[216:219], v[196:199], 0
    v_exp_f32 v163, v131
    v_exp_f32 v164, v132
    v_exp_f32 v165, v133
    v_smfmac_f32_32x32x32_bf16 v[144:159], v[208:211], v[240:247], v212
    v_exp_f32 v166, v134
    v_exp_f32 v167, v135
    v_exp_f32 v168, v136
    v_exp_f32 v169, v137
    v_exp_f32 v170, v138
    v_exp_f32 v171, v139
    v_pk_add_f32 v[160:161], v[160:161], 1.0 op_sel_hi:[1,0]
    v_pk_add_f32 v[162:163], v[162:163], 1.0 op_sel_hi:[1,0]
    v_pk_add_f32 v[164:165], v[164:165], 1.0 op_sel_hi:[1,0]
    v_pk_add_f32 v[166:167], v[166:167], 1.0 op_sel_hi:[1,0]
    v_pk_add_f32 v[168:169], v[168:169], 1.0 op_sel_hi:[1,0]
    v_pk_add_f32 v[170:171], v[170:171], 1.0 op_sel_hi:[1,0]
    s_waitcnt vmcnt(0)
    ds_read_b64_tr_b16 v[184:185], v3 offset:4096
    ds_read_b64_tr_b16 v[186:187], v3 offset:4608
    ds_read_b64_tr_b16 v[188:189], v3 offset:5120
    ds_read_b64_tr_b16 v[190:191], v3 offset:5632
    ds_read_b64_tr_b16 v[240:241], v4 offset:4096
    ds_read_b64_tr_b16 v[242:243], v4 offset:4608
    ds_read_b64_tr_b16 v[244:245], v4 offset:5120
    ds_read_b64_tr_b16 v[246:247], v4 offset:5632
    v_rcp_f32 v160, v160
    v_rcp_f32 v161, v161
    v_rcp_f32 v162, v162
    v_rcp_f32 v163, v163
    v_rcp_f32 v164, v164
    v_rcp_f32 v165, v165
    s_and_b64 exec, s[4:5], s[10:11]
    ds_write_b64 v12, v[220:221]
    s_mov_b64 exec, -1
    ds_read_b64_tr_b16 v[24:25], v13
    ds_read_b64_tr_b16 v[26:27], v14 offset:512
    ds_read_b64_tr_b16 v[28:29], v13 offset:1024
    ds_read_b64_tr_b16 v[30:31], v14 offset:1536
    s_and_b64 exec, s[4:5], s[10:11]
    ds_write_b64 v12, v[232:233]
    s_mov_b64 exec, -1
    v_rcp_f32 v166, v166
    v_rcp_f32 v167, v167
    v_rcp_f32 v168, v168
    v_rcp_f32 v169, v169
    v_rcp_f32 v170, v170
    v_rcp_f32 v171, v171
    v_pk_mul_f32 v[160:161], v[160:161], v[128:129]
    v_pk_mul_f32 v[162:163], v[162:163], v[130:131]
    v_pk_mul_f32 v[164:165], v[164:165], v[132:133]
    v_pk_mul_f32 v[166:167], v[166:167], v[134:135]
    v_pk_mul_f32 v[168:169], v[168:169], v[136:137]
    v_pk_mul_f32 v[170:171], v[170:171], v[138:139]
    v_cvt_pk_bf16_f32 v176, v160, v161
    v_cvt_pk_bf16_f32 v177, v162, v163
    v_cvt_pk_bf16_f32 v178, v164, v165
    v_cvt_pk_bf16_f32 v179, v166, v167
    v_cvt_pk_bf16_f32 v180, v168, v169
    v_cvt_pk_bf16_f32 v181, v170, v171
    s_cmp_lg_u32 s61, 0
    s_cbranch_scc1 FLUSH
PART3B:
    s_waitcnt lgkmcnt(0)
    v_exp_f32 v160, v144
    v_exp_f32 v161, v145
    v_exp_f32 v162, v146
    v_mfma_f32_32x32x16_bf16 v[128:143], v[216:219], v[200:203], 0
    v_exp_f32 v163, v147
    v_exp_f32 v164, v148
    v_exp_f32 v165, v149
    v_smfmac_f32_32x32x32_bf16 v[128:143], v[208:211], v[184:191], v212
    v_exp_f32 v166, v150
    v_exp_f32 v167, v151
    v_exp_f32 v168, v152
    v_exp_f32 v169, v153
    v_exp_f32 v170, v154
    v_exp_f32 v171, v155
    v_lshrrev_b32 v236, 7, v235
    v_and_b32 v237, 0x70, v235
    v_lshl_or_b32 v234, v236, 8, v237
    s_add_u32 m0, s22, 0
    s_add_u32 s83, s86, 0
    buffer_load_dwordx4 v234, s[40:43], s83 offen lds
    s_add_u32 m0, s22, 1024
    s_add_u32 s83, s86, 2048
    buffer_load_dwordx4 v234, s[40:43], s83 offen lds
    s_add_u32 m0, s23, 0
    s_add_u32 s83, s86, 4096
    buffer_load_dwordx4 v234, s[40:43], s83 offen lds
    s_add_u32 m0, s23, 1024
    s_add_u32 s83, s86, 6144
    buffer_load_dwordx4 v234, s[40:43], s83 offen lds
    s_cmp_lt_u32 s3, 4
    s_cbranch_scc1 EL2
    s_add_u32 s82, s87, 4096
    s_add_u32 m0, s87, 0
    s_add_u32 s83, s82, 0
    buffer_load_dwordx4 v235, s[36:39], s83 offen lds
    s_add_u32 m0, s87, 1024
    s_add_u32 s83, s82, 1024
    buffer_load_dwordx4 v235, s[36:39], s83 offen lds
    s_add_u32 m0, s87, 2048
    s_add_u32 s83, s82, 2048
    buffer_load_dwordx4 v235, s[36:39], s83 offen lds
    s_add_u32 m0, s87, 3072
    s_add_u32 s83, s82, 3072
    buffer_load_dwordx4 v235, s[36:39], s83 offen lds
    s_add_u32 m0, s87, 4096
    s_add_u32 s83, s82, 4096
    buffer_load_dwordx4 v235, s[36:39], s83 offen lds
    s_add_u32 m0, s87, 5120
    s_add_u32 s83, s82, 5120
    buffer_load_dwordx4 v235, s[36:39], s83 offen lds
    s_add_u32 m0, s87, 6144
    s_add_u32 s83, s82, 6144
    buffer_load_dwordx4 v235, s[36:39], s83 offen lds
    s_add_u32 m0, s87, 7168
    s_add_u32 s83, s82, 7168
    buffer_load_dwordx4 v235, s[36:39], s83 offen lds
EL2:
    v_pk_add_f32 v[160:161], v[160:161], 1.0 op_sel_hi:[1,0]
    v_pk_add_f32 v[162:163], v[162:163], 1.0 op_sel_hi:[1,0]
    v_pk_add_f32 v[164:165], v[164:165], 1.0 op_sel_hi:[1,0]
    v_pk_add_f32 v[166:167], v[166:167], 1.0 op_sel_hi:[1,0]
    v_pk_add_f32 v[168:169], v[168:169], 1.0 op_sel_hi:[1,0]
    v_pk_add_f32 v[170:171], v[170:171], 1.0 op_sel_hi:[1,0]
    v_rcp_f32 v160, v160
    v_rcp_f32 v161, v161
    s_cmp_lg_u32 s61, 0
    s_cbranch_scc1 SF_3_1
    v_mfma_f32_32x32x16_bf16 v[64:79], v[176:179], v[24:27], v[64:79]
    s_branch SG_3_1
SF_3_1:
    v_mfma_f32_32x32x16_bf16 v[64:79], v[176:179], v[24:27], 0
SG_3_1:
    v_rcp_f32 v162, v162
    v_rcp_f32 v163, v163
    v_rcp_f32 v164, v164
    v_rcp_f32 v165, v165
    v_mfma_f32_32x32x16_bf16 v[64:79], v[180:183], v[28:31], v[64:79]
    v_rcp_f32 v166, v166
    v_rcp_f32 v167, v167
    v_rcp_f32 v168, v168
    v_rcp_f32 v169, v169
    v_rcp_f32 v170, v170
    v_rcp_f32 v171, v171
    v_pk_mul_f32 v[160:161], v[160:161], v[144:145]
    v_pk_mul_f32 v[162:163], v[162:163], v[146:147]
    v_pk_mul_f32 v[164:165], v[164:165], v[148:149]
    v_pk_mul_f32 v[166:167], v[166:167], v[150:151]
    v_pk_mul_f32 v[168:169], v[168:169], v[152:153]
    v_pk_mul_f32 v[170:171], v[170:171], v[154:155]
    v_cvt_pk_bf16_f32 v176, v160, v161
    v_cvt_pk_bf16_f32 v177, v162, v163
    v_cvt_pk_bf16_f32 v178, v164, v165
    v_cvt_pk_bf16_f32 v179, v166, v167
    v_cvt_pk_bf16_f32 v180, v168, v169
    v_cvt_pk_bf16_f32 v181, v170, v171
    s_waitcnt lgkmcnt(0)
    v_exp_f32 v160, v128
    v_exp_f32 v161, v129
    v_exp_f32 v162, v130
    v_mfma_f32_32x32x16_bf16 v[144:159], v[216:219], v[204:207], 0
    v_exp_f32 v163, v131
    v_exp_f32 v164, v132
    v_exp_f32 v165, v133
    v_smfmac_f32_32x32x32_bf16 v[144:159], v[208:211], v[240:247], v212
    v_exp_f32 v166, v134
    v_exp_f32 v167, v135
    v_exp_f32 v168, v136
    v_exp_f32 v169, v137
    v_exp_f32 v170, v138
    v_exp_f32 v171, v139
    v_pk_add_f32 v[160:161], v[160:161], 1.0 op_sel_hi:[1,0]
    v_pk_add_f32 v[162:163], v[162:163], 1.0 op_sel_hi:[1,0]
    v_pk_add_f32 v[164:165], v[164:165], 1.0 op_sel_hi:[1,0]
    v_pk_add_f32 v[166:167], v[166:167], 1.0 op_sel_hi:[1,0]
    v_pk_add_f32 v[168:169], v[168:169], 1.0 op_sel_hi:[1,0]
    v_pk_add_f32 v[170:171], v[170:171], 1.0 op_sel_hi:[1,0]
    v_rcp_f32 v160, v160
    v_rcp_f32 v161, v161
    s_cmp_lg_u32 s61, 0
    s_cbranch_scc1 SF_3_2
    v_mfma_f32_32x32x16_bf16 v[80:95], v[176:179], v[24:27], v[80:95]
    s_branch SG_3_2
SF_3_2:
    v_mfma_f32_32x32x16_bf16 v[80:95], v[176:179], v[24:27], 0
SG_3_2:
    v_rcp_f32 v162, v162
    v_rcp_f32 v163, v163
    v_rcp_f32 v164, v164
    v_rcp_f32 v165, v165
    v_mfma_f32_32x32x16_bf16 v[80:95], v[180:183], v[28:31], v[80:95]
    v_rcp_f32 v166, v166
    v_rcp_f32 v167, v167
    v_rcp_f32 v168, v168
    v_rcp_f32 v169, v169
    v_rcp_f32 v170, v170
    v_rcp_f32 v171, v171
    v_pk_mul_f32 v[160:161], v[160:161], v[128:129]
    v_pk_mul_f32 v[162:163], v[162:163], v[130:131]
    v_pk_mul_f32 v[164:165], v[164:165], v[132:133]
    v_pk_mul_f32 v[166:167], v[166:167], v[134:135]
    v_pk_mul_f32 v[168:169], v[168:169], v[136:137]
    v_pk_mul_f32 v[170:171], v[170:171], v[138:139]
    v_cvt_pk_bf16_f32 v176, v160, v161
    v_cvt_pk_bf16_f32 v177, v162, v163
    v_cvt_pk_bf16_f32 v178, v164, v165
    v_cvt_pk_bf16_f32 v179, v166, v167
    v_cvt_pk_bf16_f32 v180, v168, v169
    v_cvt_pk_bf16_f32 v181, v170, v171
    s_waitcnt lgkmcnt(0)
    v_exp_f32 v160, v144
    v_exp_f32 v161, v145
    v_exp_f32 v162, v146
    v_exp_f32 v163, v147
    v_exp_f32 v164, v148
    v_exp_f32 v165, v149
    v_exp_f32 v166, v150
    v_exp_f32 v167, v151
    v_exp_f32 v168, v152
    v_exp_f32 v169, v153
    v_exp_f32 v170, v154
    v_exp_f32 v171, v155
    v_pk_add_f32 v[160:161], v[160:161], 1.0 op_sel_hi:[1,0]
    v_pk_add_f32 v[162:163], v[162:163], 1.0 op_sel_hi:[1,0]
    v_pk_add_f32 v[164:165], v[164:165], 1.0 op_sel_hi:[1,0]
    v_pk_add_f32 v[166:167], v[166:167], 1.0 op_sel_hi:[1,0]
    v_pk_add_f32 v[168:169], v[168:169], 1.0 op_sel_hi:[1,0]
    v_pk_add_f32 v[170:171], v[170:171], 1.0 op_sel_hi:[1,0]
    v_rcp_f32 v160, v160
    v_rcp_f32 v161, v161
    s_cmp_lg_u32 s61, 0
    s_cbranch_scc1 SF_3_3
    v_mfma_f32_32x32x16_bf16 v[96:111], v[176:179], v[24:27], v[96:111]
    s_branch SG_3_3
SF_3_3:
    v_mfma_f32_32x32x16_bf16 v[96:111], v[176:179], v[24:27], 0
SG_3_3:
    v_rcp_f32 v162, v162
    v_rcp_f32 v163, v163
    v_rcp_f32 v164, v164
    v_rcp_f32 v165, v165
    v_mfma_f32_32x32x16_bf16 v[96:111], v[180:183], v[28:31], v[96:111]
    v_rcp_f32 v166, v166
    v_rcp_f32 v167, v167
    v_rcp_f32 v168, v168
    v_rcp_f32 v169, v169
    v_rcp_f32 v170, v170
    v_rcp_f32 v171, v171
    v_pk_mul_f32 v[160:161], v[160:161], v[144:145]
    v_pk_mul_f32 v[162:163], v[162:163], v[146:147]
    v_pk_mul_f32 v[164:165], v[164:165], v[148:149]
    v_pk_mul_f32 v[166:167], v[166:167], v[150:151]
    v_pk_mul_f32 v[168:169], v[168:169], v[152:153]
    v_pk_mul_f32 v[170:171], v[170:171], v[154:155]
    v_cvt_pk_bf16_f32 v176, v160, v161
    v_cvt_pk_bf16_f32 v177, v162, v163
    v_cvt_pk_bf16_f32 v178, v164, v165
    v_cvt_pk_bf16_f32 v179, v166, v167
    v_cvt_pk_bf16_f32 v180, v168, v169
    v_cvt_pk_bf16_f32 v181, v170, v171
    s_cmp_lg_u32 s61, 0
    s_cbranch_scc1 SF_3_4
    v_mfma_f32_32x32x16_bf16 v[112:127], v[176:179], v[24:27], v[112:127]
    s_branch SG_3_4
SF_3_4:
    v_mfma_f32_32x32x16_bf16 v[112:127], v[176:179], v[24:27], 0
SG_3_4:
    v_mfma_f32_32x32x16_bf16 v[112:127], v[180:183], v[28:31], v[112:127]
    s_branch TAIL2
PART2:
    s_waitcnt lgkmcnt(0)
    v_mfma_f32_32x32x16_bf16 v[144:159], v[216:219], v[196:199], 0
    v_exp_f32 v160, v128
    v_exp_f32 v161, v129
    v_exp_f32 v162, v130
    v_exp_f32 v163, v131
    v_smfmac_f32_32x32x32_bf16 v[144:159], v[208:211], v[240:247], v212
    v_exp_f32 v164, v132
    v_exp_f32 v165, v133
    v_exp_f32 v166, v134
    v_exp_f32 v167, v135
    v_pk_add_f32 v[160:161], v[160:161], 1.0 op_sel_hi:[1,0]
    v_pk_add_f32 v[162:163], v[162:163], 1.0 op_sel_hi:[1,0]
    v_pk_add_f32 v[164:165], v[164:165], 1.0 op_sel_hi:[1,0]
    v_pk_add_f32 v[166:167], v[166:167], 1.0 op_sel_hi:[1,0]
    s_waitcnt vmcnt(0)
    ds_read_b64_tr_b16 v[184:185], v3 offset:4096
    ds_read_b64_tr_b16 v[186:187], v3 offset:4608
    ds_read_b64_tr_b16 v[188:189], v3 offset:5120
    ds_read_b64_tr_b16 v[190:191], v3 offset:5632
    ds_read_b64_tr_b16 v[240:241], v4 offset:4096
    ds_read_b64_tr_b16 v[242:243], v4 offset:4608
    ds_read_b64_tr_b16 v[244:245], v4 offset:5120
    ds_read_b64_tr_b16 v[246:247], v4 offset:5632
    v_rcp_f32 v160, v160
    v_rcp_f32 v161, v161
    v_rcp_f32 v162, v162
    v_rcp_f32 v163, v163
    s_and_b64 exec, s[4:5], s[10:11]
    ds_write_b64 v12, v[220:221]
    s_mov_b64 exec, -1
    ds_read_b64_tr_b16 v[24:25], v13
    ds_read_b64_tr_b16 v[26:27], v14 offset:512
    ds_read_b64_tr_b16 v[28:29], v13 offset:1024
    ds_read_b64_tr_b16 v[30:31], v14 offset:1536
    s_and_b64 exec, s[4:5], s[10:11]
    ds_write_b64 v12, v[232:233]
    s_mov_b64 exec, -1
    v_rcp_f32 v164, v164
    v_rcp_f32 v165, v165
    v_rcp_f32 v166, v166
    v_rcp_f32 v167, v167
    v_pk_mul_f32 v[160:161], v[160:161], v[128:129]
    v_pk_mul_f32 v[162:163], v[162:163], v[130:131]
    v_pk_mul_f32 v[164:165], v[164:165], v[132:133]
    v_pk_mul_f32 v[166:167], v[166:167], v[134:135]
    v_cvt_pk_bf16_f32 v176, v160, v161
    v_cvt_pk_bf16_f32 v177, v162, v163
    v_cvt_pk_bf16_f32 v178, v164, v165
    v_cvt_pk_bf16_f32 v179, v166, v167
    s_cmp_lg_u32 s61, 0
    s_cbranch_scc1 FLUSH
PART2B:
    s_waitcnt lgkmcnt(0)
    v_mfma_f32_32x32x16_bf16 v[128:143], v[216:219], v[200:203], 0
    v_exp_f32 v160, v144
    v_exp_f32 v161, v145
    v_exp_f32 v162, v146
    v_exp_f32 v163, v147
    v_smfmac_f32_32x32x32_bf16 v[128:143], v[208:211], v[184:191], v212
    v_exp_f32 v164, v148
    v_exp_f32 v165, v149
    v_exp_f32 v166, v150
    v_exp_f32 v167, v151
    v_lshrrev_b32 v236, 7, v235
    v_and_b32 v237, 0x70, v235
    v_lshl_or_b32 v234, v236, 8, v237
    s_add_u32 m0, s22, 0
    s_add_u32 s83, s86, 0
    buffer_load_dwordx4 v234, s[40:43], s83 offen lds
    s_add_u32 m0, s22, 1024
    s_add_u32 s83, s86, 2048
    buffer_load_dwordx4 v234, s[40:43], s83 offen lds
    s_add_u32 m0, s23, 0
    s_add_u32 s83, s86, 4096
    buffer_load_dwordx4 v234, s[40:43], s83 offen lds
    s_add_u32 m0, s23, 1024
    s_add_u32 s83, s86, 6144
    buffer_load_dwordx4 v234, s[40:43], s83 offen lds
    s_cmp_lt_u32 s3, 4
    s_cbranch_scc1 EL3
    s_add_u32 s82, s87, 4096
    s_add_u32 m0, s87, 0
    s_add_u32 s83, s82, 0
    buffer_load_dwordx4 v235, s[36:39], s83 offen lds
    s_add_u32 m0, s87, 1024
    s_add_u32 s83, s82, 1024
    buffer_load_dwordx4 v235, s[36:39], s83 offen lds
    s_add_u32 m0, s87, 2048
    s_add_u32 s83, s82, 2048
    buffer_load_dwordx4 v235, s[36:39], s83 offen lds
    s_add_u32 m0, s87, 3072
    s_add_u32 s83, s82, 3072
    buffer_load_dwordx4 v235, s[36:39], s83 offen lds
    s_add_u32 m0, s87, 4096
    s_add_u32 s83, s82, 4096
    buffer_load_dwordx4 v235, s[36:39], s83 offen lds
    s_add_u32 m0, s87, 5120
    s_add_u32 s83, s82, 5120
    buffer_load_dwordx4 v235, s[36:39], s83 offen lds
    s_add_u32 m0, s87, 6144
    s_add_u32 s83, s82, 6144
    buffer_load_dwordx4 v235, s[36:39], s83 offen lds
    s_add_u32 m0, s87, 7168
    s_add_u32 s83, s82, 7168
    buffer_load_dwordx4 v235, s[36:39], s83 offen lds
EL3:
    v_pk_add_f32 v[160:161], v[160:161], 1.0 op_sel_hi:[1,0]
    v_pk_add_f32 v[162:163], v[162:163], 1.0 op_sel_hi:[1,0]
    v_pk_add_f32 v[164:165], v[164:165], 1.0 op_sel_hi:[1,0]
    v_pk_add_f32 v[166:167], v[166:167], 1.0 op_sel_hi:[1,0]
    s_cmp_lg_u32 s61, 0
    s_cbranch_scc1 SF_2_1
    v_mfma_f32_32x32x16_bf16 v[64:79], v[176:179], v[24:27], v[64:79]
    s_branch SG_2_1
SF_2_1:
    v_mfma_f32_32x32x16_bf16 v[64:79], v[176:179], v[24:27], 0
SG_2_1:
    v_rcp_f32 v160, v160
    v_rcp_f32 v161, v161
    v_rcp_f32 v162, v162
    v_rcp_f32 v163, v163
    v_rcp_f32 v164, v164
    v_rcp_f32 v165, v165
    v_rcp_f32 v166, v166
    v_rcp_f32 v167, v167
    v_pk_mul_f32 v[160:161], v[160:161], v[144:145]
    v_pk_mul_f32 v[162:163], v[162:163], v[146:147]
    v_pk_mul_f32 v[164:165], v[164:165], v[148:149]
    v_pk_mul_f32 v[166:167], v[166:167], v[150:151]
    v_cvt_pk_bf16_f32 v176, v160, v161
    v_cvt_pk_bf16_f32 v177, v162, v163
    v_cvt_pk_bf16_f32 v178, v164, v165
    v_cvt_pk_bf16_f32 v179, v166, v167
    s_waitcnt lgkmcnt(0)
    v_mfma_f32_32x32x16_bf16 v[144:159], v[216:219], v[204:207], 0
    v_exp_f32 v160, v128
    v_exp_f32 v161, v129
    v_exp_f32 v162, v130
    v_exp_f32 v163, v131
    v_smfmac_f32_32x32x32_bf16 v[144:159], v[208:211], v[240:247], v212
    v_exp_f32 v164, v132
    v_exp_f32 v165, v133
    v_exp_f32 v166, v134
    v_exp_f32 v167, v135
    v_pk_add_f32 v[160:161], v[160:161], 1.0 op_sel_hi:[1,0]
    v_pk_add_f32 v[162:163], v[162:163], 1.0 op_sel_hi:[1,0]
    v_pk_add_f32 v[164:165], v[164:165], 1.0 op_sel_hi:[1,0]
    v_pk_add_f32 v[166:167], v[166:167], 1.0 op_sel_hi:[1,0]
    s_cmp_lg_u32 s61, 0
    s_cbranch_scc1 SF_2_2
    v_mfma_f32_32x32x16_bf16 v[80:95], v[176:179], v[24:27], v[80:95]
    s_branch SG_2_2
SF_2_2:
    v_mfma_f32_32x32x16_bf16 v[80:95], v[176:179], v[24:27], 0
SG_2_2:
    v_rcp_f32 v160, v160
    v_rcp_f32 v161, v161
    v_rcp_f32 v162, v162
    v_rcp_f32 v163, v163
    v_rcp_f32 v164, v164
    v_rcp_f32 v165, v165
    v_rcp_f32 v166, v166
    v_rcp_f32 v167, v167
    v_pk_mul_f32 v[160:161], v[160:161], v[128:129]
    v_pk_mul_f32 v[162:163], v[162:163], v[130:131]
    v_pk_mul_f32 v[164:165], v[164:165], v[132:133]
    v_pk_mul_f32 v[166:167], v[166:167], v[134:135]
    v_cvt_pk_bf16_f32 v176, v160, v161
    v_cvt_pk_bf16_f32 v177, v162, v163
    v_cvt_pk_bf16_f32 v178, v164, v165
    v_cvt_pk_bf16_f32 v179, v166, v167
    s_waitcnt lgkmcnt(0)
    v_exp_f32 v160, v144
    v_exp_f32 v161, v145
    v_exp_f32 v162, v146
    v_exp_f32 v163, v147
    v_exp_f32 v164, v148
    v_exp_f32 v165, v149
    v_exp_f32 v166, v150
    v_exp_f32 v167, v151
    v_pk_add_f32 v[160:161], v[160:161], 1.0 op_sel_hi:[1,0]
    v_pk_add_f32 v[162:163], v[162:163], 1.0 op_sel_hi:[1,0]
    v_pk_add_f32 v[164:165], v[164:165], 1.0 op_sel_hi:[1,0]
    v_pk_add_f32 v[166:167], v[166:167], 1.0 op_sel_hi:[1,0]
    s_cmp_lg_u32 s61, 0
    s_cbranch_scc1 SF_2_3
    v_mfma_f32_32x32x16_bf16 v[96:111], v[176:179], v[24:27], v[96:111]
    s_branch SG_2_3
SF_2_3:
    v_mfma_f32_32x32x16_bf16 v[96:111], v[176:179], v[24:27], 0
SG_2_3:
    v_rcp_f32 v160, v160
    v_rcp_f32 v161, v161
    v_rcp_f32 v162, v162
    v_rcp_f32 v163, v163
    v_rcp_f32 v164, v164
    v_rcp_f32 v165, v165
    v_rcp_f32 v166, v166
    v_rcp_f32 v167, v167
    v_pk_mul_f32 v[160:161], v[160:161], v[144:145]
    v_pk_mul_f32 v[162:163], v[162:163], v[146:147]
    v_pk_mul_f32 v[164:165], v[164:165], v[148:149]
    v_pk_mul_f32 v[166:167], v[166:167], v[150:151]
    v_cvt_pk_bf16_f32 v176, v160, v161
    v_cvt_pk_bf16_f32 v177, v162, v163
    v_cvt_pk_bf16_f32 v178, v164, v165
    v_cvt_pk_bf16_f32 v179, v166, v167
    s_cmp_lg_u32 s61, 0
    s_cbranch_scc1 SF_2_4
    v_mfma_f32_32x32x16_bf16 v[112:127], v[176:179], v[24:27], v[112:127]
    s_branch SG_2_4
SF_2_4:
    v_mfma_f32_32x32x16_bf16 v[112:127], v[176:179], v[24:27], 0
SG_2_4:
    s_branch TAIL2
PART1:
    s_waitcnt lgkmcnt(0)
    v_mfma_f32_32x32x16_bf16 v[144:159], v[216:219], v[196:199], 0
    v_exp_f32 v160, v128
    v_exp_f32 v161, v129
    v_exp_f32 v162, v130
    v_smfmac_f32_32x32x32_bf16 v[144:159], v[208:211], v[240:247], v212
    v_exp_f32 v163, v131
    v_pk_add_f32 v[160:161], v[160:161], 1.0 op_sel_hi:[1,0]
    v_pk_add_f32 v[162:163], v[162:163], 1.0 op_sel_hi:[1,0]
    s_waitcnt vmcnt(0)
    ds_read_b64_tr_b16 v[184:185], v3 offset:4096
    ds_read_b64_tr_b16 v[186:187], v3 offset:4608
    ds_read_b64_tr_b16 v[188:189], v3 offset:5120
    ds_read_b64_tr_b16 v[190:191], v3 offset:5632
    ds_read_b64_tr_b16 v[240:241], v4 offset:4096
    ds_read_b64_tr_b16 v[242:243], v4 offset:4608
    ds_read_b64_tr_b16 v[244:245], v4 offset:5120
    ds_read_b64_tr_b16 v[246:247], v4 offset:5632
    v_rcp_f32 v160, v160
    v_rcp_f32 v161, v161
    s_and_b64 exec, s[4:5], s[10:11]
    ds_write_b64 v12, v[220:221]
    s_mov_b64 exec, -1
    ds_read_b64_tr_b16 v[24:25], v13
    ds_read_b64_tr_b16 v[26:27], v14 offset:512
    ds_read_b64_tr_b16 v[28:29], v13 offset:1024
    ds_read_b64_tr_b16 v[30:31], v14 offset:1536
    s_and_b64 exec, s[4:5], s[10:11]
    ds_write_b64 v12, v[232:233]
    s_mov_b64 exec, -1
    v_rcp_f32 v162, v162
    v_rcp_f32 v163, v163
    v_pk_mul_f32 v[160:161], v[160:161], v[128:129]
    v_pk_mul_f32 v[162:163], v[162:163], v[130:131]
    v_cvt_pk_bf16_f32 v176, v160, v161
    v_cvt_pk_bf16_f32 v177, v162, v163
    s_cmp_lg_u32 s61, 0
    s_cbranch_scc1 FLUSH
PART1B:
    s_waitcnt lgkmcnt(0)
    v_mfma_f32_32x32x16_bf16 v[128:143], v[216:219], v[200:203], 0
    v_exp_f32 v160, v144
    v_exp_f32 v161, v145
    v_exp_f32 v162, v146
    v_smfmac_f32_32x32x32_bf16 v[128:143], v[208:211], v[184:191], v212
    v_exp_f32 v163, v147
    v_lshrrev_b32 v236, 7, v235
    v_and_b32 v237, 0x70, v235
    v_lshl_or_b32 v234, v236, 8, v237
    s_add_u32 m0, s22, 0
    s_add_u32 s83, s86, 0
    buffer_load_dwordx4 v234, s[40:43], s83 offen lds
    s_add_u32 m0, s22, 1024
    s_add_u32 s83, s86, 2048
    buffer_load_dwordx4 v234, s[40:43], s83 offen lds
    s_add_u32 m0, s23, 0
    s_add_u32 s83, s86, 4096
    buffer_load_dwordx4 v234, s[40:43], s83 offen lds
    s_add_u32 m0, s23, 1024
    s_add_u32 s83, s86, 6144
    buffer_load_dwordx4 v234, s[40:43], s83 offen lds
    s_cmp_lt_u32 s3, 4
    s_cbranch_scc1 EL4
    s_add_u32 s82, s87, 4096
    s_add_u32 m0, s87, 0
    s_add_u32 s83, s82, 0
    buffer_load_dwordx4 v235, s[36:39], s83 offen lds
    s_add_u32 m0, s87, 1024
    s_add_u32 s83, s82, 1024
    buffer_load_dwordx4 v235, s[36:39], s83 offen lds
    s_add_u32 m0, s87, 2048
    s_add_u32 s83, s82, 2048
    buffer_load_dwordx4 v235, s[36:39], s83 offen lds
    s_add_u32 m0, s87, 3072
    s_add_u32 s83, s82, 3072
    buffer_load_dwordx4 v235, s[36:39], s83 offen lds
    s_add_u32 m0, s87, 4096
    s_add_u32 s83, s82, 4096
    buffer_load_dwordx4 v235, s[36:39], s83 offen lds
    s_add_u32 m0, s87, 5120
    s_add_u32 s83, s82, 5120
    buffer_load_dwordx4 v235, s[36:39], s83 offen lds
    s_add_u32 m0, s87, 6144
    s_add_u32 s83, s82, 6144
    buffer_load_dwordx4 v235, s[36:39], s83 offen lds
    s_add_u32 m0, s87, 7168
    s_add_u32 s83, s82, 7168
    buffer_load_dwordx4 v235, s[36:39], s83 offen lds
EL4:
    v_pk_add_f32 v[160:161], v[160:161], 1.0 op_sel_hi:[1,0]
    v_pk_add_f32 v[162:163], v[162:163], 1.0 op_sel_hi:[1,0]
    s_cmp_lg_u32 s61, 0
    s_cbranch_scc1 SF_1_1
    v_mfma_f32_32x32x16_bf16 v[64:79], v[176:179], v[24:27], v[64:79]
    s_branch SG_1_1
SF_1_1:
    v_mfma_f32_32x32x16_bf16 v[64:79], v[176:179], v[24:27], 0
SG_1_1:
    v_rcp_f32 v160, v160
    v_rcp_f32 v161, v161
    v_rcp_f32 v162, v162
    v_rcp_f32 v163, v163
    v_pk_mul_f32 v[160:161], v[160:161], v[144:145]
    v_pk_mul_f32 v[162:163], v[162:163], v[146:147]
    v_cvt_pk_bf16_f32 v176, v160, v161
    v_cvt_pk_bf16_f32 v177, v162, v163
    s_waitcnt lgkmcnt(0)
    v_mfma_f32_32x32x16_bf16 v[144:159], v[216:219], v[204:207], 0
    v_exp_f32 v160, v128
    v_exp_f32 v161, v129
    v_exp_f32 v162, v130
    v_smfmac_f32_32x32x32_bf16 v[144:159], v[208:211], v[240:247], v212
    v_exp_f32 v163, v131
    v_pk_add_f32 v[160:161], v[160:161], 1.0 op_sel_hi:[1,0]
    v_pk_add_f32 v[162:163], v[162:163], 1.0 op_sel_hi:[1,0]
    s_cmp_lg_u32 s61, 0
    s_cbranch_scc1 SF_1_2
    v_mfma_f32_32x32x16_bf16 v[80:95], v[176:179], v[24:27], v[80:95]
    s_branch SG_1_2
SF_1_2:
    v_mfma_f32_32x32x16_bf16 v[80:95], v[176:179], v[24:27], 0
SG_1_2:
    v_rcp_f32 v160, v160
    v_rcp_f32 v161, v161
    v_rcp_f32 v162, v162
    v_rcp_f32 v163, v163
    v_pk_mul_f32 v[160:161], v[160:161], v[128:129]
    v_pk_mul_f32 v[162:163], v[162:163], v[130:131]
    v_cvt_pk_bf16_f32 v176, v160, v161
    v_cvt_pk_bf16_f32 v177, v162, v163
    s_waitcnt lgkmcnt(0)
    v_exp_f32 v160, v144
    v_exp_f32 v161, v145
    v_exp_f32 v162, v146
    v_exp_f32 v163, v147
    v_pk_add_f32 v[160:161], v[160:161], 1.0 op_sel_hi:[1,0]
    v_pk_add_f32 v[162:163], v[162:163], 1.0 op_sel_hi:[1,0]
    s_cmp_lg_u32 s61, 0
    s_cbranch_scc1 SF_1_3
    v_mfma_f32_32x32x16_bf16 v[96:111], v[176:179], v[24:27], v[96:111]
    s_branch SG_1_3
SF_1_3:
    v_mfma_f32_32x32x16_bf16 v[96:111], v[176:179], v[24:27], 0
SG_1_3:
    v_rcp_f32 v160, v160
    v_rcp_f32 v161, v161
    v_rcp_f32 v162, v162
    v_rcp_f32 v163, v163
    v_pk_mul_f32 v[160:161], v[160:161], v[144:145]
    v_pk_mul_f32 v[162:163], v[162:163], v[146:147]
    v_cvt_pk_bf16_f32 v176, v160, v161
    v_cvt_pk_bf16_f32 v177, v162, v163
    s_cmp_lg_u32 s61, 0
    s_cbranch_scc1 SF_1_4
    v_mfma_f32_32x32x16_bf16 v[112:127], v[176:179], v[24:27], v[112:127]
    s_branch SG_1_4
SF_1_4:
    v_mfma_f32_32x32x16_bf16 v[112:127], v[176:179], v[24:27], 0
SG_1_4:
    s_branch TAIL2
PRET:
    s_cmp_eq_u32 s70, 0
    s_cbranch_scc1 PART1B
    s_cmp_eq_u32 s70, 1
    s_cbranch_scc1 PART2B
    s_cmp_eq_u32 s70, 2
    s_cbranch_scc1 PART3B
    s_branch PART4B
TAIL1:
    v_lshrrev_b32 v236, 7, v235
    v_and_b32 v237, 0x70, v235
    v_lshl_or_b32 v234, v236, 8, v237
    s_waitcnt vmcnt(0) lgkmcnt(0)
    s_add_u32 m0, s22, 0
    s_add_u32 s83, s86, 0
    buffer_load_dwordx4 v234, s[40:43], s83 offen lds
    s_add_u32 m0, s22, 1024
    s_add_u32 s83, s86, 2048
    buffer_load_dwordx4 v234, s[40:43], s83 offen lds
    s_add_u32 m0, s23, 0
    s_add_u32 s83, s86, 4096
    buffer_load_dwordx4 v234, s[40:43], s83 offen lds
    s_add_u32 m0, s23, 1024
    s_add_u32 s83, s86, 6144
    buffer_load_dwordx4 v234, s[40:43], s83 offen lds
    s_cmp_lt_u32 s3, 4
    s_cbranch_scc1 EL5
    s_add_u32 s82, s87, 4096
    s_add_u32 m0, s87, 0
    s_add_u32 s83, s82, 0
    buffer_load_dwordx4 v235, s[36:39], s83 offen lds
    s_add_u32 m0, s87, 1024
    s_add_u32 s83, s82, 1024
    buffer_load_dwordx4 v235, s[36:39], s83 offen lds
    s_add_u32 m0, s87, 2048
    s_add_u32 s83, s82, 2048
    buffer_load_dwordx4 v235, s[36:39], s83 offen lds
    s_add_u32 m0, s87, 3072
    s_add_u32 s83, s82, 3072
    buffer_load_dwordx4 v235, s[36:39], s83 offen lds
    s_add_u32 m0, s87, 4096
    s_add_u32 s83, s82, 4096
    buffer_load_dwordx4 v235, s[36:39], s83 offen lds
    s_add_u32 m0, s87, 5120
    s_add_u32 s83, s82, 5120
    buffer_load_dwordx4 v235, s[36:39], s83 offen lds
    s_add_u32 m0, s87, 6144
    s_add_u32 s83, s82, 6144
    buffer_load_dwordx4 v235, s[36:39], s83 offen lds
    s_add_u32 m0, s87, 7168
    s_add_u32 s83, s82, 7168
    buffer_load_dwordx4 v235, s[36:39], s83 offen lds
EL5:
TAIL2:
    s_mov_b32 s19, s69
    s_mov_b32 s13, 0
    s_cmp_eq_u32 s3, 7
    s_cbranch_scc1 SPIND
    s_lshl_b32 s82, s3, 2
    v_mov_b32 v236, s82
    s_mov_b32 s83, 0x1000000
SPIN:
    ds_read_b32 v237, v236 offset:2660
    s_waitcnt lgkmcnt(0)
    v_readfirstlane_b32 s82, v237
    s_nop 0
    s_cmp_eq_u32 s82, s63
    s_cbranch_scc1 SPIND
    s_sub_u32 s83, s83, 1
    s_cbranch_scc0 SPIN
SPIND:
    s_cmp_lg_u32 s64, 0
    s_cbranch_scc1 FLUSH
    s_add_u32 s83, s17, 445
    v_subrev_u32 v236, s17, v15
    v_subrev_u32 v237, s17, v18
    v_and_b32 v236, 7, v236
    v_and_b32 v237, 7, v237
    v_add_u32 v236, s83, v236
    v_add_u32 v237, s83, v237
    v_mad_u32_u24 v236, v236, s67, v17
    v_mad_u32_u24 v239, v237, s67, v19
    ds_read_b64_tr_b16 v[222:223], v236 offset:0
    ds_read_b64_tr_b16 v[224:225], v236 offset:64
    ds_read_b64_tr_b16 v[226:227], v236 offset:128
    ds_read_b64_tr_b16 v[228:229], v236 offset:192
    ds_read_b32 v192, v239
    ds_read_b128 v[160:163], v213 offset:2816
    ds_read_b128 v[164:167], v213 offset:2880
    ds_read_b128 v[168:171], v213 offset:2944
    ds_read_b128 v[172:175], v213 offset:3008
    v_mov_b32 v193, 0
    s_add_u32 s83, s18, 445
    v_subrev_u32 v238, s83, v237
    s_sub_u32 s82, s19, s18
    v_cmp_ge_u32 vcc, s82, v238
    v_mad_u32_u24 v237, v237, s67, v22
    v_lshrrev_b32 v1, 4, v235
    s_lshl_b32 s14, s3, 6
    v_add_u32 v0, s14, v1
    v_lshrrev_b32 v28, 5, v1
    v_lshlrev_b32 v28, 9, v28
    v_and_b32 v24, 31, v1
    v_lshl_or_b32 v28, v24, 2, v28
    v_add_u32 v26, s22, v28
    v_add_u32 v28, s23, v28
    v_add_u32 v27, 0x400, v26
    v_add_u32 v29, 0x400, v28
    v_add_u32 v30, s22, v235
    v_add_u32 v181, s23, v235
    s_and_b64 s[80:81], vcc, s[78:79]
    s_and_b64 s[6:7], vcc, s[8:9]
    s_waitcnt lgkmcnt(5)
    v_mfma_f32_32x32x16_bf16 v[64:79], v[222:225], v[230:233], v[64:79]
    s_add_u32 s14, s85, 445
    v_add_u32 v24, s14, v24
    v_mad_u32_u24 v24, v24, s67, v22
    s_and_b32 s14, s3, 1
    s_lshl_b32 s14, s14, 14
    s_add_u32 s14, s14, 61440
    v_add_u32 v25, s14, v235
    s_lshl_b32 s14, s75, 6
    v_mfma_f32_32x32x16_bf16 v[80:95], v[224:227], v[230:233], v[80:95]
    s_add_u32 s14, s14, 147692
    v_mov_b32 v180, s14
    s_mul_i32 s14, s84, 3
    s_min_u32 s15, s14, 168
    s_cmp_lt_u32 s3, 4
    s_cselect_b32 s14, s15, s14
    s_cselect_b32 s15, 0, 88
    v_subrev_u32 v176, s15, v0
    v_cmp_gt_u32 s[4:5], s14, v176
    s_movk_i32 s14, 21846
    v_mfma_f32_32x32x16_bf16 v[96:111], v[226:229], v[230:233], v[96:111]
    v_cndmask_b32 v176, 0, v176, s[4:5]
    v_mul_u32_u24 v177, s14, v176
    v_lshrrev_b32 v177, 16, v177
    v_mul_u32_u24 v178, 3, v177
    v_sub_u32 v178, v176, v178
    v_lshlrev_b32 v31, 2, v178
    v_add_u32 v179, 445, v177
    v_mad_u32_u24 v179, v179, s67, v31
    v_mfma_f32_32x32x16_bf16 v[112:127], v[228:231], v[230:233], v[112:127]
    v_lshl_add_u32 v177, v177, 3, v31
    v_lshrrev_b32 v178, 1, v178
    s_movk_i32 s14, 776
    v_mad_u32_u24 v177, v178, s14, v177
    v_lshlrev_b32 v176, 1, v176
    s_waitcnt vmcnt(0) lgkmcnt(0)
    ds_read2_b32 v[144:145], v26 offset0:0 offset1:32
    ds_read2_b32 v[146:147], v26 offset0:64 offset1:96
    ds_read2_b32 v[148:149], v27 offset0:0 offset1:32
    ds_read2_b32 v[150:151], v27 offset0:64 offset1:96
    ds_read2_b32 v[152:153], v28 offset0:0 offset1:32
    ds_read2_b32 v[154:155], v28 offset0:64 offset1:96
    ds_read2_b32 v[156:157], v29 offset0:0 offset1:32
    ds_read2_b32 v[158:159], v29 offset0:64 offset1:96
    ds_read_b32 v177, v177
    ds_read_b32 v180, v180
    v_cvt_pk_bf16_f32 v64, v64, v65
    v_cvt_pk_bf16_f32 v65, v66, v67
    v_cvt_pk_bf16_f32 v66, v68, v69
    v_cvt_pk_bf16_f32 v67, v70, v71
    v_cvt_pk_bf16_f32 v68, v72, v73
    v_cvt_pk_bf16_f32 v69, v74, v75
    v_cvt_pk_bf16_f32 v70, v76, v77
    v_cvt_pk_bf16_f32 v71, v78, v79
    v_cvt_pk_bf16_f32 v80, v80, v81
    v_cvt_pk_bf16_f32 v81, v82, v83
    v_smfmac_f32_32x32x32_bf16 v[192:207], v[160:163], v[64:71], v214
    v_cvt_pk_bf16_f32 v82, v84, v85
    v_cvt_pk_bf16_f32 v83, v86, v87
    v_cvt_pk_bf16_f32 v84, v88, v89
    v_cvt_pk_bf16_f32 v85, v90, v91
    v_cvt_pk_bf16_f32 v86, v92, v93
    v_cvt_pk_bf16_f32 v87, v94, v95
    v_cvt_pk_bf16_f32 v96, v96, v97
    v_cvt_pk_bf16_f32 v97, v98, v99
    v_smfmac_f32_32x32x32_bf16 v[192:207], v[164:167], v[80:87], v214
    v_cvt_pk_bf16_f32 v98, v100, v101
    v_cvt_pk_bf16_f32 v99, v102, v103
    v_cvt_pk_bf16_f32 v100, v104, v105
    v_cvt_pk_bf16_f32 v101, v106, v107
    v_cvt_pk_bf16_f32 v102, v108, v109
    v_cvt_pk_bf16_f32 v103, v110, v111
    v_cvt_pk_bf16_f32 v112, v112, v113
    v_cvt_pk_bf16_f32 v113, v114, v115
    v_smfmac_f32_32x32x32_bf16 v[192:207], v[168:171], v[96:103], v214
    v_cvt_pk_bf16_f32 v114, v116, v117
    v_cvt_pk_bf16_f32 v115, v118, v119
    v_cvt_pk_bf16_f32 v116, v120, v121
    v_cvt_pk_bf16_f32 v117, v122, v123
    v_cvt_pk_bf16_f32 v118, v124, v125
    v_cvt_pk_bf16_f32 v119, v126, v127
    s_mov_b64 exec, s[80:81]
    ds_write_b128 v237, v[64:67]
    v_smfmac_f32_32x32x32_bf16 v[192:207], v[172:175], v[112:119], v214
    ds_write_b128 v237, v[68:71] offset:32
    ds_write_b128 v237, v[80:83] offset:64
    ds_write_b128 v237, v[84:87] offset:96
    ds_write_b128 v237, v[96:99] offset:128
    ds_write_b128 v237, v[100:103] offset:160
    ds_write_b128 v237, v[112:115] offset:192
    ds_write_b128 v237, v[116:119] offset:224
    s_mov_b64 exec, s[6:7]
    s_nop 3
    v_add_f32 v23, v192, v193
    ds_write_b32 v239, v23
    s_lshl_b32 s82, s3, 2
    s_mov_b64 exec, 1
    v_mov_b32 v236, s82
    v_mov_b32 v237, s63
    ds_write_b32 v236, v237 offset:2656
    s_mov_b64 exec, -1
    s_lshr_b32 s83, s3, 2
    s_lshl_b32 s83, s83, 2
    s_mov_b64 exec, 1
    v_mov_b32 v236, s83
    v_mov_b32 v238, 1
    ds_add_u32 v236, v238 offset:2632
    s_mov_b64 exec, -1
    s_waitcnt lgkmcnt(11)
    v_lshlrev_b32 v128, 16, v144
    v_and_b32 v144, 0xffff0000, v144
    v_lshlrev_b32 v129, 16, v145
    v_and_b32 v145, 0xffff0000, v145
    v_lshlrev_b32 v130, 16, v146
    v_and_b32 v146, 0xffff0000, v146
    v_lshlrev_b32 v131, 16, v147
    v_and_b32 v147, 0xffff0000, v147
    v_lshlrev_b32 v132, 16, v148
    v_and_b32 v148, 0xffff0000, v148
    v_lshlrev_b32 v133, 16, v149
    v_and_b32 v149, 0xffff0000, v149
    v_lshlrev_b32 v134, 16, v150
    v_and_b32 v150, 0xffff0000, v150
    v_lshlrev_b32 v135, 16, v151
    v_and_b32 v151, 0xffff0000, v151
    v_lshlrev_b32 v136, 16, v152
    v_and_b32 v152, 0xffff0000, v152
    v_lshlrev_b32 v137, 16, v153
    v_and_b32 v153, 0xffff0000, v153
    v_lshlrev_b32 v138, 16, v154
    v_and_b32 v154, 0xffff0000, v154
    v_lshlrev_b32 v139, 16, v155
    v_and_b32 v155, 0xffff0000, v155
    v_lshlrev_b32 v140, 16, v156
    v_and_b32 v156, 0xffff0000, v156
    v_lshlrev_b32 v141, 16, v157
    v_and_b32 v157, 0xffff0000, v157
    v_lshlrev_b32 v142, 16, v158
    v_and_b32 v158, 0xffff0000, v158
    v_lshlrev_b32 v143, 16, v159
    v_and_b32 v159, 0xffff0000, v159
    s_branch EPREP
EMPTY_WAVE:
    s_lshl_b32 s82, s3, 2
    s_mov_b64 exec, 1
    v_mov_b32 v236, s82
    v_mov_b32 v237, s63
    ds_write_b32 v236, v237 offset:2656
    s_mov_b64 exec, -1
    v_lshrrev_b32 v236, 7, v235
    v_and_b32 v237, 0x70, v235
    v_lshl_or_b32 v234, v236, 8, v237
    s_waitcnt vmcnt(0) lgkmcnt(0)
    s_add_u32 m0, s22, 0
    s_add_u32 s83, s86, 0
    buffer_load_dwordx4 v234, s[40:43], s83 offen lds
    s_add_u32 m0, s22, 1024
    s_add_u32 s83, s86, 2048
    buffer_load_dwordx4 v234, s[40:43], s83 offen lds
    s_add_u32 m0, s23, 0
    s_add_u32 s83, s86, 4096
    buffer_load_dwordx4 v234, s[40:43], s83 offen lds
    s_add_u32 m0, s23, 1024
    s_add_u32 s83, s86, 6144
    buffer_load_dwordx4 v234, s[40:43], s83 offen lds
    s_cmp_lt_u32 s3, 4
    s_cbranch_scc1 EL6
    s_add_u32 s82, s87, 4096
    s_add_u32 m0, s87, 0
    s_add_u32 s83, s82, 0
    buffer_load_dwordx4 v235, s[36:39], s83 offen lds
    s_add_u32 m0, s87, 1024
    s_add_u32 s83, s82, 1024
    buffer_load_dwordx4 v235, s[36:39], s83 offen lds
    s_add_u32 m0, s87, 2048
    s_add_u32 s83, s82, 2048
    buffer_load_dwordx4 v235, s[36:39], s83 offen lds
    s_add_u32 m0, s87, 3072
    s_add_u32 s83, s82, 3072
    buffer_load_dwordx4 v235, s[36:39], s83 offen lds
    s_add_u32 m0, s87, 4096
    s_add_u32 s83, s82, 4096
    buffer_load_dwordx4 v235, s[36:39], s83 offen lds
    s_add_u32 m0, s87, 5120
    s_add_u32 s83, s82, 5120
    buffer_load_dwordx4 v235, s[36:39], s83 offen lds
    s_add_u32 m0, s87, 6144
    s_add_u32 s83, s82, 6144
    buffer_load_dwordx4 v235, s[36:39], s83 offen lds
    s_add_u32 m0, s87, 7168
    s_add_u32 s83, s82, 7168
    buffer_load_dwordx4 v235, s[36:39], s83 offen lds
EL6:
WAVE_DONE:
    v_lshrrev_b32 v1, 4, v235
    s_lshl_b32 s14, s3, 6
    v_add_u32 v0, s14, v1
    v_lshrrev_b32 v28, 5, v1
    v_lshlrev_b32 v28, 9, v28
    v_and_b32 v24, 31, v1
    v_lshl_or_b32 v28, v24, 2, v28
    v_add_u32 v26, s22, v28
    v_add_u32 v28, s23, v28
    v_add_u32 v27, 0x400, v26
    v_add_u32 v29, 0x400, v28
    v_add_u32 v30, s22, v235
    v_add_u32 v181, s23, v235
    s_add_u32 s14, s85, 445
    v_add_u32 v24, s14, v24
    v_mad_u32_u24 v24, v24, s67, v22
    s_and_b32 s14, s3, 1
    s_lshl_b32 s14, s14, 14
    s_add_u32 s14, s14, 61440
    v_add_u32 v25, s14, v235
    s_lshl_b32 s14, s75, 6
    s_add_u32 s14, s14, 147692
    v_mov_b32 v180, s14
    s_mul_i32 s14, s84, 3
    s_min_u32 s15, s14, 168
    s_cmp_lt_u32 s3, 4
    s_cselect_b32 s14, s15, s14
    s_cselect_b32 s15, 0, 88
    v_subrev_u32 v176, s15, v0
    v_cmp_gt_u32 s[4:5], s14, v176
    s_movk_i32 s14, 21846
    s_nop 0
    v_cndmask_b32 v176, 0, v176, s[4:5]
    v_mul_u32_u24 v177, s14, v176
    v_lshrrev_b32 v177, 16, v177
    v_mul_u32_u24 v178, 3, v177
    v_sub_u32 v178, v176, v178
    v_lshlrev_b32 v31, 2, v178
    v_add_u32 v179, 445, v177
    v_mad_u32_u24 v179, v179, s67, v31
    v_lshl_add_u32 v177, v177, 3, v31
    v_lshrrev_b32 v178, 1, v178
    s_movk_i32 s14, 776
    v_mad_u32_u24 v177, v178, s14, v177
    v_lshlrev_b32 v176, 1, v176
    s_waitcnt vmcnt(0) lgkmcnt(0)
    s_lshr_b32 s83, s3, 2
    s_lshl_b32 s83, s83, 2
    s_mov_b64 exec, 1
    v_mov_b32 v236, s83
    v_mov_b32 v238, 1
    ds_add_u32 v236, v238 offset:2632
    s_mov_b64 exec, -1
    ds_read2_b32 v[144:145], v26 offset0:0 offset1:32
    ds_read2_b32 v[146:147], v26 offset0:64 offset1:96
    ds_read2_b32 v[148:149], v27 offset0:0 offset1:32
    ds_read2_b32 v[150:151], v27 offset0:64 offset1:96
    ds_read2_b32 v[152:153], v28 offset0:0 offset1:32
    ds_read2_b32 v[154:155], v28 offset0:64 offset1:96
    ds_read2_b32 v[156:157], v29 offset0:0 offset1:32
    ds_read2_b32 v[158:159], v29 offset0:64 offset1:96
    ds_read_b32 v177, v177
    ds_read_b32 v180, v180
    s_waitcnt lgkmcnt(0)
    v_lshlrev_b32 v128, 16, v144
    v_and_b32 v144, 0xffff0000, v144
    v_lshlrev_b32 v129, 16, v145
    v_and_b32 v145, 0xffff0000, v145
    v_lshlrev_b32 v130, 16, v146
    v_and_b32 v146, 0xffff0000, v146
    v_lshlrev_b32 v131, 16, v147
    v_and_b32 v147, 0xffff0000, v147
    v_lshlrev_b32 v132, 16, v148
    v_and_b32 v148, 0xffff0000, v148
    v_lshlrev_b32 v133, 16, v149
    v_and_b32 v149, 0xffff0000, v149
    v_lshlrev_b32 v134, 16, v150
    v_and_b32 v150, 0xffff0000, v150
    v_lshlrev_b32 v135, 16, v151
    v_and_b32 v151, 0xffff0000, v151
    v_lshlrev_b32 v136, 16, v152
    v_and_b32 v152, 0xffff0000, v152
    v_lshlrev_b32 v137, 16, v153
    v_and_b32 v153, 0xffff0000, v153
    v_lshlrev_b32 v138, 16, v154
    v_and_b32 v154, 0xffff0000, v154
    v_lshlrev_b32 v139, 16, v155
    v_and_b32 v155, 0xffff0000, v155
    v_lshlrev_b32 v140, 16, v156
    v_and_b32 v156, 0xffff0000, v156
    v_lshlrev_b32 v141, 16, v157
    v_and_b32 v157, 0xffff0000, v157
    v_lshlrev_b32 v142, 16, v158
    v_and_b32 v158, 0xffff0000, v158
    v_lshlrev_b32 v143, 16, v159
    v_and_b32 v159, 0xffff0000, v159
EPREP:
    v_readfirstlane_b32 s82, v180
    v_mov_b32 v162, 0
    s_bfe_u32 s82, s82, 0x70003
    s_cmp_ge_u32 s82, 56
    s_cselect_b32 s61, 4, 0
    s_cmp_lt_u32 s3, 4
    s_cselect_b32 s61, 4, s61
    s_cmp_eq_u32 s64, 0
    s_cbranch_scc1 EWAIT
    s_barrier
    s_add_u32 s65, s65, 1
    s_lshl_b32 s82, s65, 10
    s_cmp_lt_u32 s82, s2
    s_cbranch_scc1 SLOW_BATCH
    s_branch EPI
EWAIT:
    s_mov_b32 s14, 0x1000000
EW2:
    ds_read_b64 v[160:161], v162 offset:2632
    s_waitcnt lgkmcnt(0)
    v_readfirstlane_b32 s82, v160
    v_readfirstlane_b32 s83, v161
    s_cmp_lt_u32 s82, s61
    s_cselect_b32 s83, 0, s83
    s_cmp_ge_u32 s83, 4
    s_cbranch_scc1 EW3
    s_setprio 0
    s_sub_u32 s14, s14, 1
    s_cbranch_scc0 EW2
EW3:
    s_setprio 0
EPI:
    v_mov_b32 v236, v176
    v_mov_b32 v237, v177
    v_mov_b32 v23, v181
    ds_read_b128 v[160:163], v24 offset:0
    ds_read_b128 v[64:67], v25 offset:0
    ds_read_b128 v[164:167], v24 offset:32
    ds_read_b128 v[68:71], v25 offset:1024
    ds_read_b128 v[168:171], v24 offset:64
    ds_read_b128 v[72:75], v25 offset:2048
    ds_read_b128 v[172:175], v24 offset:96
    ds_read_b128 v[76:79], v25 offset:3072
    ds_read_b32 v239, v179 offset:256
    s_mov_b32 s76, 0xbf317218
    s_mov_b32 s77, 0xbf317218
    s_mov_b32 s78, 0xbfb8aa3b
    s_mov_b32 s79, 0xbfb8aa3b
    s_waitcnt lgkmcnt(7)
    v_mfma_f32_32x32x16_bf16 v[32:47], v[160:163], v[64:67], v[32:47]
    ds_read_b128 v[176:179], v24 offset:128
    ds_read_b128 v[80:83], v25 offset:4096
    s_waitcnt lgkmcnt(7)
    v_mfma_f32_32x32x16_bf16 v[32:47], v[164:167], v[68:71], v[32:47]
    ds_read_b128 v[180:183], v24 offset:160
    ds_read_b128 v[84:87], v25 offset:5120
    s_waitcnt lgkmcnt(7)
    v_mfma_f32_32x32x16_bf16 v[32:47], v[168:171], v[72:75], v[32:47]
    ds_read_b128 v[184:187], v24 offset:192
    ds_read_b128 v[88:91], v25 offset:6144
    s_waitcnt lgkmcnt(7)
    v_mfma_f32_32x32x16_bf16 v[32:47], v[172:175], v[76:79], v[32:47]
    ds_read_b128 v[188:191], v24 offset:224
    ds_read_b128 v[92:95], v25 offset:7168
    s_waitcnt lgkmcnt(6)
    v_mfma_f32_32x32x16_bf16 v[32:47], v[176:179], v[80:83], v[32:47]
    ds_read_b128 v[96:99], v25 offset:8192
    ds_read_b128 v[100:103], v25 offset:9216
    s_waitcnt lgkmcnt(6)
    v_mfma_f32_32x32x16_bf16 v[32:47], v[180:183], v[84:87], v[32:47]
    ds_read_b128 v[104:107], v25 offset:10240
    ds_read_b128 v[108:111], v25 offset:11264
    s_mov_b64 exec, s[4:5]
    s_cbranch_execz NOPOS
    v_fma_f32 v239, v239, s76, v237
    v_cvt_pk_bf16_f32 v239, v239, v239
    buffer_store_short v239, v236, s[52:55], 0 offen sc1
NOPOS:
    s_mov_b64 exec, -1
    s_waitcnt lgkmcnt(6)
    v_mfma_f32_32x32x16_bf16 v[32:47], v[184:187], v[88:91], v[32:47]
    ds_read_b128 v[112:115], v25 offset:12288
    ds_read_b128 v[116:119], v25 offset:13312
    s_waitcnt lgkmcnt(6)
    v_mfma_f32_32x32x16_bf16 v[32:47], v[188:191], v[92:95], v[32:47]
    ds_read_b128 v[120:123], v25 offset:14336
    ds_read_b128 v[124:127], v25 offset:15360
    s_waitcnt lgkmcnt(0)
    v_mfma_f32_32x32x16_bf16 v[48:63], v[160:163], v[96:99], v[48:63]
    v_mfma_f32_32x32x16_bf16 v[48:63], v[164:167], v[100:103], v[48:63]
    s_cmp_ge_u32 s3, 2
    s_cbranch_scc1 EPI3
    s_nop 4
    v_exp_f32 v192, v32
    v_exp_f32 v193, v33
    v_mfma_f32_32x32x16_bf16 v[48:63], v[168:171], v[104:107], v[48:63]
    v_exp_f32 v194, v34
    v_exp_f32 v195, v35
    v_exp_f32 v196, v36
    v_exp_f32 v197, v37
    v_mfma_f32_32x32x16_bf16 v[48:63], v[172:175], v[108:111], v[48:63]
    v_exp_f32 v198, v38
    v_exp_f32 v199, v39
    v_exp_f32 v200, v40
    v_exp_f32 v201, v41
    v_mfma_f32_32x32x16_bf16 v[48:63], v[176:179], v[112:115], v[48:63]
    v_exp_f32 v202, v42
    v_exp_f32 v203, v43
    v_exp_f32 v204, v44
    v_exp_f32 v205, v45
    v_exp_f32 v206, v46
    v_exp_f32 v207, v47
    v_fma_f32 v192, v192, s78, s78
    v_fma_f32 v193, v193, s78, s78
    v_fma_f32 v194, v194, s78, s78
    v_fma_f32 v195, v195, s78, s78
    v_fma_f32 v196, v196, s78, s78
    v_fma_f32 v197, v197, s78, s78
    v_fma_f32 v198, v198, s78, s78
    v_fma_f32 v199, v199, s78, s78
    v_fma_f32 v200, v200, s78, s78
    v_fma_f32 v201, v201, s78, s78
    v_fma_f32 v202, v202, s78, s78
    v_fma_f32 v203, v203, s78, s78
    v_fma_f32 v204, v204, s78, s78
    v_fma_f32 v205, v205, s78, s78
    v_fma_f32 v206, v206, s78, s78
    v_fma_f32 v207, v207, s78, s78
    v_mfma_f32_32x32x16_bf16 v[48:63], v[180:183], v[116:119], v[48:63]
    v_rcp_f32 v192, v192
    v_rcp_f32 v193, v193
    v_rcp_f32 v194, v194
    v_rcp_f32 v195, v195
    v_mfma_f32_32x32x16_bf16 v[48:63], v[184:187], v[120:123], v[48:63]
    v_rcp_f32 v196, v196
    v_rcp_f32 v197, v197
    v_rcp_f32 v198, v198
    v_rcp_f32 v199, v199
    v_mfma_f32_32x32x16_bf16 v[48:63], v[188:191], v[124:127], v[48:63]
    v_rcp_f32 v200, v200
    v_rcp_f32 v201, v201
    v_rcp_f32 v202, v202
    v_rcp_f32 v203, v203
    v_rcp_f32 v204, v204
    v_rcp_f32 v205, v205
    v_rcp_f32 v206, v206
    v_rcp_f32 v207, v207
    v_pk_fma_f32 v[128:129], v[192:193], v[32:33], v[128:129]
    v_pk_fma_f32 v[130:131], v[194:195], v[34:35], v[130:131]
    v_pk_fma_f32 v[132:133], v[196:197], v[36:37], v[132:133]
    v_pk_fma_f32 v[134:135], v[198:199], v[38:39], v[134:135]
    v_pk_fma_f32 v[136:137], v[200:201], v[40:41], v[136:137]
    v_pk_fma_f32 v[138:139], v[202:203], v[42:43], v[138:139]
    v_pk_fma_f32 v[140:141], v[204:205], v[44:45], v[140:141]
    v_pk_fma_f32 v[142:143], v[206:207], v[46:47], v[142:143]
    v_exp_f32 v192, v48
    v_exp_f32 v193, v49
    v_exp_f32 v194, v50
    v_exp_f32 v195, v51
    v_pk_fma_f32 v[192:193], v[192:193], s[78:79], s[78:79]
    v_pk_fma_f32 v[194:195], v[194:195], s[78:79], s[78:79]
    v_rcp_f32 v192, v192
    v_rcp_f32 v193, v193
    v_rcp_f32 v194, v194
    v_rcp_f32 v195, v195
    v_pk_fma_f32 v[144:145], v[192:193], v[48:49], v[144:145]
    v_pk_fma_f32 v[146:147], v[194:195], v[50:51], v[146:147]
    v_cvt_pk_bf16_f32 v208, v128, v144
    v_cvt_pk_bf16_f32 v209, v129, v145
    v_cvt_pk_bf16_f32 v210, v130, v146
    v_cvt_pk_bf16_f32 v211, v131, v147
    ds_write2_b32 v26, v208, v209 offset0:0 offset1:32
    ds_write2_b32 v26, v210, v211 offset0:64 offset1:96
    ds_read_b128 v[240:243], v30 offset:0
    v_exp_f32 v192, v52
    v_exp_f32 v193, v53
    v_exp_f32 v194, v54
    v_exp_f32 v195, v55
    s_add_u32 s83, s86, 0
    v_pk_fma_f32 v[192:193], v[192:193], s[78:79], s[78:79]
    v_pk_fma_f32 v[194:195], v[194:195], s[78:79], s[78:79]
    v_rcp_f32 v192, v192
    v_rcp_f32 v193, v193
    v_rcp_f32 v194, v194
    v_rcp_f32 v195, v195
    s_waitcnt lgkmcnt(0)
    buffer_store_dwordx4 v[240:243], v234, s[48:51], s83 offen sc1
    v_pk_fma_f32 v[148:149], v[192:193], v[52:53], v[148:149]
    v_pk_fma_f32 v[150:151], v[194:195], v[54:55], v[150:151]
    v_cvt_pk_bf16_f32 v208, v132, v148
    v_cvt_pk_bf16_f32 v209, v133, v149
    v_cvt_pk_bf16_f32 v210, v134, v150
    v_cvt_pk_bf16_f32 v211, v135, v151
    ds_write2_b32 v27, v208, v209 offset0:0 offset1:32
    ds_write2_b32 v27, v210, v211 offset0:64 offset1:96
    ds_read_b128 v[244:247], v30 offset:1024
    v_exp_f32 v192, v56
    v_exp_f32 v193, v57
    v_exp_f32 v194, v58
    v_exp_f32 v195, v59
    s_add_u32 s83, s86, 2048
    v_pk_fma_f32 v[192:193], v[192:193], s[78:79], s[78:79]
    v_pk_fma_f32 v[194:195], v[194:195], s[78:79], s[78:79]
    v_rcp_f32 v192, v192
    v_rcp_f32 v193, v193
    v_rcp_f32 v194, v194
    v_rcp_f32 v195, v195
    s_waitcnt lgkmcnt(0)
    buffer_store_dwordx4 v[244:247], v234, s[48:51], s83 offen sc1
    v_pk_fma_f32 v[152:153], v[192:193], v[56:57], v[152:153]
    v_pk_fma_f32 v[154:155], v[194:195], v[58:59], v[154:155]
    v_cvt_pk_bf16_f32 v208, v136, v152
    v_cvt_pk_bf16_f32 v209, v137, v153
    v_cvt_pk_bf16_f32 v210, v138, v154
    v_cvt_pk_bf16_f32 v211, v139, v155
    ds_write2_b32 v28, v208, v209 offset0:0 offset1:32
    ds_write2_b32 v28, v210, v211 offset0:64 offset1:96
    ds_read_b128 v[248:251], v23 offset:0
    v_exp_f32 v192, v60
    v_exp_f32 v193, v61
    v_exp_f32 v194, v62
    v_exp_f32 v195, v63
    s_add_u32 s83, s86, 4096
    v_pk_fma_f32 v[192:193], v[192:193], s[78:79], s[78:79]
    v_pk_fma_f32 v[194:195], v[194:195], s[78:79], s[78:79]
    v_rcp_f32 v192, v192
    v_rcp_f32 v193, v193
    v_rcp_f32 v194, v194
    v_rcp_f32 v195, v195
    s_waitcnt lgkmcnt(0)
    buffer_store_dwordx4 v[248:251], v234, s[48:51], s83 offen sc1
    v_pk_fma_f32 v[156:157], v[192:193], v[60:61], v[156:157]
    v_pk_fma_f32 v[158:159], v[194:195], v[62:63], v[158:159]
    v_cvt_pk_bf16_f32 v208, v140, v156
    v_cvt_pk_bf16_f32 v209, v141, v157
    v_cvt_pk_bf16_f32 v210, v142, v158
    v_cvt_pk_bf16_f32 v211, v143, v159
    ds_write2_b32 v29, v208, v209 offset0:0 offset1:32
    ds_write2_b32 v29, v210, v211 offset0:64 offset1:96
    ds_read_b128 v[252:255], v23 offset:1024
    s_add_u32 s83, s86, 6144
    s_waitcnt lgkmcnt(0)
    buffer_store_dwordx4 v[252:255], v234, s[48:51], s83 offen sc1
    s_branch K2_FIN
EPI3:
    s_nop 4
    v_exp_f32 v192, v32
    v_exp_f32 v193, v33
    v_mfma_f32_32x32x16_bf16 v[48:63], v[168:171], v[104:107], v[48:63]
    v_exp_f32 v194, v34
    v_exp_f32 v195, v35
    v_exp_f32 v196, v36
    v_exp_f32 v197, v37
    v_mfma_f32_32x32x16_bf16 v[48:63], v[172:175], v[108:111], v[48:63]
    v_exp_f32 v198, v38
    v_exp_f32 v199, v39
    v_exp_f32 v200, v40
    v_exp_f32 v201, v41
    v_mfma_f32_32x32x16_bf16 v[48:63], v[176:179], v[112:115], v[48:63]
    v_exp_f32 v202, v42
    v_exp_f32 v203, v43
    v_fma_f32 v192, v192, s78, s78
    v_fma_f32 v193, v193, s78, s78
    v_fma_f32 v194, v194, s78, s78
    v_fma_f32 v195, v195, s78, s78
    v_fma_f32 v196, v196, s78, s78
    v_fma_f32 v197, v197, s78, s78
    v_fma_f32 v198, v198, s78, s78
    v_fma_f32 v199, v199, s78, s78
    v_fma_f32 v200, v200, s78, s78
    v_fma_f32 v201, v201, s78, s78
    v_fma_f32 v202, v202, s78, s78
    v_fma_f32 v203, v203, s78, s78
    v_mfma_f32_32x32x16_bf16 v[48:63], v[180:183], v[116:119], v[48:63]
    v_rcp_f32 v192, v192
    v_rcp_f32 v193, v193
    v_rcp_f32 v194, v194
    v_rcp_f32 v195, v195
    v_mfma_f32_32x32x16_bf16 v[48:63], v[184:187], v[120:123], v[48:63]
    v_rcp_f32 v196, v196
    v_rcp_f32 v197, v197
    v_rcp_f32 v198, v198
    v_rcp_f32 v199, v199
    v_mfma_f32_32x32x16_bf16 v[48:63], v[188:191], v[124:127], v[48:63]
    v_rcp_f32 v200, v200
    v_rcp_f32 v201, v201
    v_rcp_f32 v202, v202
    v_rcp_f32 v203, v203
    v_pk_fma_f32 v[128:129], v[192:193], v[32:33], v[128:129]
    v_pk_fma_f32 v[130:131], v[194:195], v[34:35], v[130:131]
    v_pk_fma_f32 v[132:133], v[196:197], v[36:37], v[132:133]
    v_pk_fma_f32 v[134:135], v[198:199], v[38:39], v[134:135]
    v_pk_fma_f32 v[136:137], v[200:201], v[40:41], v[136:137]
    v_pk_fma_f32 v[138:139], v[202:203], v[42:43], v[138:139]
    s_nop 1
    v_exp_f32 v192, v48
    v_exp_f32 v193, v49
    v_exp_f32 v194, v50
    v_exp_f32 v195, v51
    v_pk_fma_f32 v[192:193], v[192:193], s[78:79], s[78:79]
    v_pk_fma_f32 v[194:195], v[194:195], s[78:79], s[78:79]
    v_rcp_f32 v192, v192
    v_rcp_f32 v193, v193
    v_rcp_f32 v194, v194
    v_rcp_f32 v195, v195
    v_pk_fma_f32 v[144:145], v[192:193], v[48:49], v[144:145]
    v_pk_fma_f32 v[146:147], v[194:195], v[50:51], v[146:147]
    v_cvt_pk_bf16_f32 v208, v128, v144
    v_cvt_pk_bf16_f32 v209, v129, v145
    v_cvt_pk_bf16_f32 v210, v130, v146
    v_cvt_pk_bf16_f32 v211, v131, v147
    ds_write2_b32 v26, v208, v209 offset0:0 offset1:32
    ds_write2_b32 v26, v210, v211 offset0:64 offset1:96
    ds_read_b128 v[240:243], v30 offset:0
    v_exp_f32 v192, v52
    v_exp_f32 v193, v53
    v_exp_f32 v194, v54
    v_exp_f32 v195, v55
    s_add_u32 s83, s86, 0
    v_pk_fma_f32 v[192:193], v[192:193], s[78:79], s[78:79]
    v_pk_fma_f32 v[194:195], v[194:195], s[78:79], s[78:79]
    v_rcp_f32 v192, v192
    v_rcp_f32 v193, v193
    v_rcp_f32 v194, v194
    v_rcp_f32 v195, v195
    s_waitcnt lgkmcnt(0)
    buffer_store_dwordx4 v[240:243], v234, s[48:51], s83 offen sc1
    v_pk_fma_f32 v[148:149], v[192:193], v[52:53], v[148:149]
    v_pk_fma_f32 v[150:151], v[194:195], v[54:55], v[150:151]
    v_cvt_pk_bf16_f32 v208, v132, v148
    v_cvt_pk_bf16_f32 v209, v133, v149
    v_cvt_pk_bf16_f32 v210, v134, v150
    v_cvt_pk_bf16_f32 v211, v135, v151
    ds_write2_b32 v27, v208, v209 offset0:0 offset1:32
    ds_write2_b32 v27, v210, v211 offset0:64 offset1:96
    ds_read_b128 v[244:247], v30 offset:1024
    v_exp_f32 v192, v56
    v_exp_f32 v193, v57
    v_exp_f32 v194, v58
    v_exp_f32 v195, v59
    s_add_u32 s83, s86, 2048
    v_pk_fma_f32 v[192:193], v[192:193], s[78:79], s[78:79]
    v_pk_fma_f32 v[194:195], v[194:195], s[78:79], s[78:79]
    v_rcp_f32 v192, v192
    v_rcp_f32 v193, v193
    v_rcp_f32 v194, v194
    v_rcp_f32 v195, v195
    s_waitcnt lgkmcnt(0)
    buffer_store_dwordx4 v[244:247], v234, s[48:51], s83 offen sc1
    v_pk_fma_f32 v[152:153], v[192:193], v[56:57], v[152:153]
    v_pk_fma_f32 v[154:155], v[194:195], v[58:59], v[154:155]
    v_cvt_pk_bf16_f32 v208, v136, v152
    v_cvt_pk_bf16_f32 v209, v137, v153
    v_cvt_pk_bf16_f32 v210, v138, v154
    v_cvt_pk_bf16_f32 v211, v139, v155
    ds_write2_b32 v28, v208, v209 offset0:0 offset1:32
    ds_write2_b32 v28, v210, v211 offset0:64 offset1:96
    ds_read_b128 v[248:251], v23 offset:0
    s_add_u32 s83, s86, 4096
    s_waitcnt lgkmcnt(0)
    buffer_store_dwordx4 v[248:251], v234, s[48:51], s83 offen sc1
K2_FIN:
K2_END:
    s_endpgm
SLOW_ENTRY:
    s_waitcnt lgkmcnt(0)
    s_mov_b32 s64, 1
    s_mov_b32 s65, 0
SLOW_BATCH:
    v_lshrrev_b32 v237, 1, v0
    v_lshlrev_b32 v238, 4, v237
    s_lshr_b32 s82, s26, 2
    s_lshl_b32 s82, s82, 12
    s_and_b32 s83, s26, 3
    s_lshl_b32 s83, s83, 2
    s_add_u32 s82, s82, s83
    buffer_load_dword v20, v238, s[56:59], s82 offen
    s_add_u32 s63, s65, 1
    v_lshlrev_b32 v24, 2, v0
    v_mov_b32 v25, 0
    v_cmpx_gt_u32 vcc, 0x80, v0
    ds_write_b32 v24, v25 offset:1568
    s_mov_b64 exec, -1
    v_lshrrev_b32 v24, 1, v0
    s_movk_i32 s82, 1568
    s_waitcnt vmcnt(0)
    v_and_b32 v26, 0xffff, v20
    v_mad_u32_u24 v26, v24, s82, v26
    v_lshrrev_b32 v25, 16, v20
    v_lshlrev_b32 v24, 2, v24
    ds_write_b32 v24, v25 offset:3072
    ds_write_b32 v24, v26 offset:5120
    s_waitcnt lgkmcnt(0)
    s_barrier
    ds_read_b128 v[128:131], v235 offset:3072
    s_waitcnt lgkmcnt(0)
    v_add_u32 v129, v128, v129
    v_add_u32 v130, v129, v130
    v_add_u32 v131, v130, v131
    v_mov_b32 v132, v131
    s_nop 1
    v_add_u32_dpp v132, v132, v132 row_shr:1 row_mask:0xf bank_mask:0xf bound_ctrl:1
    s_nop 1
    v_add_u32_dpp v132, v132, v132 row_shr:2 row_mask:0xf bank_mask:0xf bound_ctrl:1
    s_nop 1
    v_add_u32_dpp v132, v132, v132 row_shr:4 row_mask:0xf bank_mask:0xf bound_ctrl:1
    s_nop 1
    v_add_u32_dpp v132, v132, v132 row_shr:8 row_mask:0xf bank_mask:0xf bound_ctrl:1
    s_nop 1
    v_add_u32_dpp v132, v132, v132 row_bcast:15 row_mask:0xa bank_mask:0xf
    s_nop 1
    v_add_u32_dpp v132, v132, v132 row_bcast:31 row_mask:0xc bank_mask:0xf
    s_nop 0
    v_readlane_b32 s2, v132, 63
    v_sub_u32 v136, v132, v131
    v_add_u32 v137, v136, v128
    v_add_u32 v138, v136, v129
    v_add_u32 v139, v136, v130
    ds_write_b128 v235, v[136:139] offset:4096
    s_lshl_b32 s82, s65, 10
    v_add_u32 v140, s82, v0
    v_add_u32 v141, 0x200, v140
    v_mov_b32 v142, 0
    v_mov_b32 v143, 0
    v_add_u32 v144, 512, v142
    ds_read_b32 v146, v144 offset:4096
    v_add_u32 v145, 512, v143
    ds_read_b32 v147, v145 offset:4096
    s_waitcnt lgkmcnt(0)
    v_cmp_le_u32 vcc, v146, v140
    s_nop 1
    v_cndmask_b32 v142, v142, v144, vcc
    v_cmp_le_u32 vcc, v147, v141
    s_nop 1
    v_cndmask_b32 v143, v143, v145, vcc
    v_add_u32 v144, 256, v142
    ds_read_b32 v146, v144 offset:4096
    v_add_u32 v145, 256, v143
    ds_read_b32 v147, v145 offset:4096
    s_waitcnt lgkmcnt(0)
    v_cmp_le_u32 vcc, v146, v140
    s_nop 1
    v_cndmask_b32 v142, v142, v144, vcc
    v_cmp_le_u32 vcc, v147, v141
    s_nop 1
    v_cndmask_b32 v143, v143, v145, vcc
    v_add_u32 v144, 128, v142
    ds_read_b32 v146, v144 offset:4096
    v_add_u32 v145, 128, v143
    ds_read_b32 v147, v145 offset:4096
    s_waitcnt lgkmcnt(0)
    v_cmp_le_u32 vcc, v146, v140
    s_nop 1
    v_cndmask_b32 v142, v142, v144, vcc
    v_cmp_le_u32 vcc, v147, v141
    s_nop 1
    v_cndmask_b32 v143, v143, v145, vcc
    v_add_u32 v144, 64, v142
    ds_read_b32 v146, v144 offset:4096
    v_add_u32 v145, 64, v143
    ds_read_b32 v147, v145 offset:4096
    s_waitcnt lgkmcnt(0)
    v_cmp_le_u32 vcc, v146, v140
    s_nop 1
    v_cndmask_b32 v142, v142, v144, vcc
    v_cmp_le_u32 vcc, v147, v141
    s_nop 1
    v_cndmask_b32 v143, v143, v145, vcc
    v_add_u32 v144, 32, v142
    ds_read_b32 v146, v144 offset:4096
    v_add_u32 v145, 32, v143
    ds_read_b32 v147, v145 offset:4096
    s_waitcnt lgkmcnt(0)
    v_cmp_le_u32 vcc, v146, v140
    s_nop 1
    v_cndmask_b32 v142, v142, v144, vcc
    v_cmp_le_u32 vcc, v147, v141
    s_nop 1
    v_cndmask_b32 v143, v143, v145, vcc
    v_add_u32 v144, 16, v142
    ds_read_b32 v146, v144 offset:4096
    v_add_u32 v145, 16, v143
    ds_read_b32 v147, v145 offset:4096
    s_waitcnt lgkmcnt(0)
    v_cmp_le_u32 vcc, v146, v140
    s_nop 1
    v_cndmask_b32 v142, v142, v144, vcc
    v_cmp_le_u32 vcc, v147, v141
    s_nop 1
    v_cndmask_b32 v143, v143, v145, vcc
    v_add_u32 v144, 8, v142
    ds_read_b32 v146, v144 offset:4096
    v_add_u32 v145, 8, v143
    ds_read_b32 v147, v145 offset:4096
    s_waitcnt lgkmcnt(0)
    v_cmp_le_u32 vcc, v146, v140
    s_nop 1
    v_cndmask_b32 v142, v142, v144, vcc
    v_cmp_le_u32 vcc, v147, v141
    s_nop 1
    v_cndmask_b32 v143, v143, v145, vcc
    v_add_u32 v144, 4, v142
    ds_read_b32 v146, v144 offset:4096
    v_add_u32 v145, 4, v143
    ds_read_b32 v147, v145 offset:4096
    s_waitcnt lgkmcnt(0)
    v_cmp_le_u32 vcc, v146, v140
    s_nop 1
    v_cndmask_b32 v142, v142, v144, vcc
    v_cmp_le_u32 vcc, v147, v141
    s_nop 1
    v_cndmask_b32 v143, v143, v145, vcc
    ds_read_b32 v144, v142 offset:4096
    ds_read_b32 v146, v142 offset:5120
    ds_read_b32 v145, v143 offset:4096
    ds_read_b32 v147, v143 offset:5120
    v_mov_b32 v21, 0
    s_waitcnt lgkmcnt(0)
    v_sub_u32 v144, v140, v144
    v_add_lshl_u32 v144, v144, v146, 3
    v_cmpx_gt_u32 vcc, s2, v140
    v_mov_b32 v21, 1
    buffer_load_dwordx2 v[128:129], v144, s[32:35], 0 offen
    v_sub_u32 v145, v141, v145
    v_add_lshl_u32 v145, v145, v147, 3
    v_cmpx_gt_u32 vcc, s2, v141
    v_mov_b32 v21, 2
    buffer_load_dwordx2 v[130:131], v145, s[32:35], 0 offen
    s_mov_b64 exec, -1
    s_waitcnt vmcnt(0)
    v_mov_b32 v23, 1
    v_cmpx_lt_i32 vcc, 0, v21
    v_and_b32 v134, 0x1fc, v128
    ds_add_rtn_u32 v132, v134, v23 offset:1568
    v_cmpx_lt_i32 vcc, 1, v21
    v_and_b32 v135, 0x1fc, v130
    ds_add_rtn_u32 v133, v135, v23 offset:1568
H_S:
    s_mov_b64 exec, -1
    s_waitcnt lgkmcnt(0)
    s_barrier
    v_lshrrev_b32 v150, 1, v235
    ds_read_b64 v[136:137], v150 offset:1568
    s_waitcnt lgkmcnt(0)
    v_add_u32 v137, v136, v137
    v_mov_b32 v139, v137
    s_nop 1
    v_add_u32_dpp v139, v139, v139 row_shr:1 row_mask:0xf bank_mask:0xf bound_ctrl:1
    s_nop 1
    v_add_u32_dpp v139, v139, v139 row_shr:2 row_mask:0xf bank_mask:0xf bound_ctrl:1
    s_nop 1
    v_add_u32_dpp v139, v139, v139 row_shr:4 row_mask:0xf bank_mask:0xf bound_ctrl:1
    s_nop 1
    v_add_u32_dpp v139, v139, v139 row_shr:8 row_mask:0xf bank_mask:0xf bound_ctrl:1
    s_nop 1
    v_add_u32_dpp v139, v139, v139 row_bcast:15 row_mask:0xa bank_mask:0xf
    s_nop 1
    v_add_u32_dpp v139, v139, v139 row_bcast:31 row_mask:0xc bank_mask:0xf
    v_sub_u32 v140, v139, v137
    s_nop 1
    v_mov_b32_dpp v141, v140 quad_perm:[0,0,0,0] row_mask:0xf bank_mask:0xf
    v_mov_b32_dpp v142, v139 quad_perm:[3,3,3,3] row_mask:0xf bank_mask:0xf
    v_sub_u32 v140, v140, v141
    v_sub_u32 v142, v142, v141
    v_add_u32 v143, 31, v142
    v_and_b32 v143, -32, v143
    v_and_b32 v144, 3, v1
    v_cmp_eq_u32 vcc, 0, v144
    s_nop 1
    v_cndmask_b32 v144, 0, v143, vcc
    s_nop 1
    v_add_u32_dpp v144, v144, v144 row_shr:1 row_mask:0xf bank_mask:0xf bound_ctrl:1
    s_nop 1
    v_add_u32_dpp v144, v144, v144 row_shr:2 row_mask:0xf bank_mask:0xf bound_ctrl:1
    s_nop 1
    v_add_u32_dpp v144, v144, v144 row_shr:4 row_mask:0xf bank_mask:0xf bound_ctrl:1
    s_nop 1
    v_add_u32_dpp v144, v144, v144 row_shr:8 row_mask:0xf bank_mask:0xf bound_ctrl:1
    s_nop 1
    v_add_u32_dpp v144, v144, v144 row_bcast:15 row_mask:0xa bank_mask:0xf
    s_nop 1
    v_add_u32_dpp v144, v144, v144 row_bcast:31 row_mask:0xc bank_mask:0xf
    s_nop 0
    v_readlane_b32 s12, v144, 63
    v_sub_u32 v145, v144, v143
    v_add_u32 v146, v145, v140
    v_add_u32 v146, 18462, v146
    v_add_u32 v147, v146, v136
    ds_write_b64 v150, v[146:147] offset:2080
    v_add_u32 v145, v145, v142
    v_mov_b32 v148, 0
    v_readlane_b32 s82, v145, 0
    v_readlane_b32 s83, v144, 0
    v_mov_b32 v149, 0x7f000038
    v_add_u32 v24, s82, v1
    v_cmpx_gt_u32 vcc, s83, v24
    v_add_u32 v24, 18462, v24
    v_lshlrev_b32 v24, 3, v24
    ds_write_b64 v24, v[148:149]
    s_mov_b64 exec, -1
    v_readlane_b32 s82, v145, 4
    v_readlane_b32 s83, v144, 4
    v_mov_b32 v149, 0x7f000078
    v_add_u32 v24, s82, v1
    v_cmpx_gt_u32 vcc, s83, v24
    v_add_u32 v24, 18462, v24
    v_lshlrev_b32 v24, 3, v24
    ds_write_b64 v24, v[148:149]
    s_mov_b64 exec, -1
    v_readlane_b32 s82, v145, 8
    v_readlane_b32 s83, v144, 8
    v_mov_b32 v149, 0x7f0000b8
    v_add_u32 v24, s82, v1
    v_cmpx_gt_u32 vcc, s83, v24
    v_add_u32 v24, 18462, v24
    v_lshlrev_b32 v24, 3, v24
    ds_write_b64 v24, v[148:149]
    s_mov_b64 exec, -1
    v_readlane_b32 s82, v145, 12
    v_readlane_b32 s83, v144, 12
    v_mov_b32 v149, 0x7f0000f8
    v_add_u32 v24, s82, v1
    v_cmpx_gt_u32 vcc, s83, v24
    v_add_u32 v24, 18462, v24
    v_lshlrev_b32 v24, 3, v24
    ds_write_b64 v24, v[148:149]
    s_mov_b64 exec, -1
    v_readlane_b32 s82, v145, 16
    v_readlane_b32 s83, v144, 16
    v_mov_b32 v149, 0x7f000138
    v_add_u32 v24, s82, v1
    v_cmpx_gt_u32 vcc, s83, v24
    v_add_u32 v24, 18462, v24
    v_lshlrev_b32 v24, 3, v24
    ds_write_b64 v24, v[148:149]
    s_mov_b64 exec, -1
    v_readlane_b32 s82, v145, 20
    v_readlane_b32 s83, v144, 20
    v_mov_b32 v149, 0x7f000178
    v_add_u32 v24, s82, v1
    v_cmpx_gt_u32 vcc, s83, v24
    v_add_u32 v24, 18462, v24
    v_lshlrev_b32 v24, 3, v24
    ds_write_b64 v24, v[148:149]
    s_mov_b64 exec, -1
    v_readlane_b32 s82, v145, 24
    v_readlane_b32 s83, v144, 24
    v_mov_b32 v149, 0x7f0001b8
    v_add_u32 v24, s82, v1
    v_cmpx_gt_u32 vcc, s83, v24
    v_add_u32 v24, 18462, v24
    v_lshlrev_b32 v24, 3, v24
    ds_write_b64 v24, v[148:149]
    s_mov_b64 exec, -1
    v_readlane_b32 s82, v145, 28
    v_readlane_b32 s83, v144, 28
    v_mov_b32 v149, 0x7f0001f8
    v_add_u32 v24, s82, v1
    v_cmpx_gt_u32 vcc, s83, v24
    v_add_u32 v24, 18462, v24
    v_lshlrev_b32 v24, 3, v24
    ds_write_b64 v24, v[148:149]
    s_mov_b64 exec, -1
    v_readlane_b32 s82, v145, 32
    v_readlane_b32 s83, v144, 32
    v_mov_b32 v149, 0x7f000238
    v_add_u32 v24, s82, v1
    v_cmpx_gt_u32 vcc, s83, v24
    v_add_u32 v24, 18462, v24
    v_lshlrev_b32 v24, 3, v24
    ds_write_b64 v24, v[148:149]
    s_mov_b64 exec, -1
    v_readlane_b32 s82, v145, 36
    v_readlane_b32 s83, v144, 36
    v_mov_b32 v149, 0x7f000278
    v_add_u32 v24, s82, v1
    v_cmpx_gt_u32 vcc, s83, v24
    v_add_u32 v24, 18462, v24
    v_lshlrev_b32 v24, 3, v24
    ds_write_b64 v24, v[148:149]
    s_mov_b64 exec, -1
    v_readlane_b32 s82, v145, 40
    v_readlane_b32 s83, v144, 40
    v_mov_b32 v149, 0x7f0002b8
    v_add_u32 v24, s82, v1
    v_cmpx_gt_u32 vcc, s83, v24
    v_add_u32 v24, 18462, v24
    v_lshlrev_b32 v24, 3, v24
    ds_write_b64 v24, v[148:149]
    s_mov_b64 exec, -1
    v_readlane_b32 s82, v145, 44
    v_readlane_b32 s83, v144, 44
    v_mov_b32 v149, 0x7f0002f8
    v_add_u32 v24, s82, v1
    v_cmpx_gt_u32 vcc, s83, v24
    v_add_u32 v24, 18462, v24
    v_lshlrev_b32 v24, 3, v24
    ds_write_b64 v24, v[148:149]
    s_mov_b64 exec, -1
    v_readlane_b32 s82, v145, 48
    v_readlane_b32 s83, v144, 48
    v_mov_b32 v149, 0x7f000308
    v_add_u32 v24, s82, v1
    v_cmpx_gt_u32 vcc, s83, v24
    v_add_u32 v24, 18462, v24
    v_lshlrev_b32 v24, 3, v24
    ds_write_b64 v24, v[148:149]
    s_mov_b64 exec, -1
    v_cmpx_lt_i32 vcc, 0, v21
    ds_read_b32 v134, v134 offset:2080
    v_cmpx_lt_i32 vcc, 1, v21
    ds_read_b32 v135, v135 offset:2080
SC1_S:
    s_mov_b64 exec, -1
    s_waitcnt lgkmcnt(0)
    v_cmpx_lt_i32 vcc, 0, v21
    v_add_lshl_u32 v134, v134, v132, 3
    ds_write_b64 v134, v[128:129]
    v_cmpx_lt_i32 vcc, 1, v21
    v_add_lshl_u32 v135, v135, v133, 3
    ds_write_b64 v135, v[130:131]
SC2_S:
    s_mov_b64 exec, -1
    s_waitcnt lgkmcnt(0)
    s_barrier
    s_lshr_b32 s82, s12, 5
    s_lshr_b32 s70, s82, 3
    s_and_b32 s82, s82, 7
    s_mul_i32 s14, s70, s3
    s_min_u32 s83, s3, s82
    s_add_u32 s14, s14, s83
    s_cmp_lt_u32 s3, s82
    s_addc_u32 s70, s70, 0
    s_lshl_b32 s14, s14, 2
    s_lshl_b32 s70, s70, 2
    s_add_u32 s13, s70, 3
    s_lshr_b32 s13, s13, 2
    s_add_u32 s70, s70, 3
    s_and_b32 s70, s70, 3
    s_lshl_b32 s74, s70, 3
    s_add_u32 s74, s74, 7
    s_sub_u32 s82, 31, s74
    s_lshr_b32 s72, -1, s82
    s_mov_b32 s73, 0
    s_cmp_eq_u32 s13, 1
    s_cselect_b32 s10, s72, -1
    s_cselect_b32 s71, s74, 31
    s_lshl_b32 s82, s14, 6
    s_add_u32 s82, s82, 147696
    v_and_b32 v8, 31, v1
    v_lshl_add_u32 v8, v8, 3, s82
    v_and_b32 v9, 0x38, v1
    v_add3_u32 v9, v9, s82, 4
    v_mov_b32 v30, 0
    s_branch FIRST
CODE_END:
    s_endpgm
.section .rodata,"a"
.p2align 6
.amdhsa_kernel gather_scatter__cheap_equivariant_egnn__graph_kernel
  .amdhsa_next_free_vgpr 256
  .amdhsa_next_free_sgpr 102
  .amdhsa_accum_offset 256
  .amdhsa_group_segment_fixed_size 0
  .amdhsa_kernarg_size 88
  .amdhsa_user_sgpr_count 2
  .amdhsa_user_sgpr_kernarg_segment_ptr 1
  .amdhsa_system_sgpr_workgroup_id_x 1
  .amdhsa_float_denorm_mode_32 3
.end_amdhsa_kernel
```
